```python
import torch

def _softmax(x, axis=-1):
    return torch.softmax(x, dim=axis)
def _gelu(x):
    return torch.nn.functional.gelu(x, approximate="tanh")
def _silu(x):
    return torch.nn.functional.silu(x)
def _sigmoid(x):
    return torch.sigmoid(x)
def _layernorm(x, axis=-1, eps=1e-5):
    m = x.mean(dim=axis, keepdim=True)
    v = x.var(dim=axis, keepdim=True, unbiased=False)
    return (x - m) / torch.sqrt(v + eps)
def _scatter_add(tgt, idx, src, axis=0):
    return tgt.clone().index_add_(axis, idx, src)
def _segment_sum(src, seg, n):
    out = torch.zeros((n,) + src.shape[1:], dtype=src.dtype)
    return out.index_add_(0, seg, src)
def _pad(x, pw):
    flat = tuple(v for pair in reversed(pw) for v in pair)
    return torch.nn.functional.pad(x, flat)

kernel_name = 'sequential_preLN__mha_block__glu_gated_geglu__prompt'

def setup_inputs():

    _w = (lambda a: (lambda t: t.to(torch.bfloat16) if t.is_floating_point() else t)(torch.as_tensor(a)))
    def _A_setup():
        B, S, D, H = 1, 2048, 1024, 32
        return {
            "x": _w((lambda *s: torch.randn(*s, dtype=torch.bfloat16) * 0.05)(B, S, D)),
            "wqkv": _w((lambda *s: torch.randn(*s, dtype=torch.bfloat16) * 0.05)(D, 3 * D)),
            "wo": _w((lambda *s: torch.randn(*s, dtype=torch.bfloat16) * 0.05)(D, D)),
        }
    _A_in = _A_setup()

    def _B_setup():
        B, S, Dm, Df = 1, 2048, 1024, 3584
        return {
            "x": _w((lambda *s: torch.randn(*s, dtype=torch.bfloat16) * 0.05)(B, S, Dm)),
            "w_gate": _w((lambda *s: torch.randn(*s, dtype=torch.bfloat16) * 0.8)(Dm, Df) * (Dm ** -0.5)),
            "w_up": _w((lambda *s: torch.randn(*s, dtype=torch.bfloat16) * 0.8)(Dm, Df) * (Dm ** -0.5)),
            "w_down": _w((lambda *s: torch.randn(*s, dtype=torch.bfloat16) * 0.8)(Df, Dm) * (Df ** -0.5)),
        }
    _B_in = _B_setup()

    return {
        "A_x": _A_in["x"],
        "A_wqkv": _A_in["wqkv"],
        "A_wo": _A_in["wo"],
        "B_x": _B_in["x"],
        "B_w_gate": _B_in["w_gate"],
        "B_w_up": _B_in["w_up"],
        "B_w_down": _B_in["w_down"],
    }

def reference(A_x, A_wqkv, A_wo, B_x, B_w_gate, B_w_up, B_w_down):
    def _A_ref(x, wqkv, wo):
        B, S, D = x.shape
        H = 32
        Dh = D // H
        qkv = (lambda x, *d: x.permute(*d))((x @ wqkv).reshape(B, S, 3, H, Dh), 2, 0, 3, 1, 4)
        q, k, v = qkv[0], qkv[1], qkv[2]
        scores = torch.einsum("bhqd,bhkd->bhqk", q, k) * (Dh ** -0.5)
        p = _softmax(scores, axis=-1)
        o = torch.einsum("bhqk,bhkd->bhqd", p, v)
        return (lambda x, *d: x.permute(*d))(o, 0, 2, 1, 3).reshape(B, S, D) @ wo

    def _B_ref(x, w_gate, w_up, w_down):
        g = torch.einsum("bsd,df->bsf", x, w_gate)
        u = torch.einsum("bsd,df->bsf", x, w_up)
        h = _gelu(g) * u
        return torch.einsum("bsf,fd->bsd", h, w_down)

    x = A_x
    h = x + _A_ref(_layernorm(x, axis=-1), A_wqkv, A_wo)
    h2 = h + _B_ref(_layernorm(h, axis=-1), B_w_gate, B_w_up, B_w_down)
    return h2
```

```asm
; @launch kernel=qkv_kernel grid=(256,1,1) block=(512,1,1) lds=125952
; @launch kernel=attn_kernel grid=(256,1,1) block=(768,1,1) lds=147712
; @launch kernel=wo_kernel grid=(256,1,1) block=(256,1,1) lds=147456
; @launch kernel=gu_kernel grid=(256,1,1) block=(512,1,1) lds=157696
; @launch kernel=down_kernel grid=(256,1,1) block=(256,1,1) lds=86016
.amdgcn_target "amdgcn-amd-amdhsa--gfx950"
.text
.globl qkv_kernel
.p2align 8
.type qkv_kernel,@function
qkv_kernel:
    s_cmp_ge_u32 s2, 256
    s_cbranch_scc1 K1_END
    s_load_dwordx2 s[40:41], s[0:1], 8
    s_load_dwordx2 s[42:43], s[0:1], 72
    s_load_dwordx2 s[44:45], s[0:1], 0
    v_lshrrev_b32 v1, 6, v0
    v_and_b32 v0, 63, v0
    v_readfirstlane_b32 s3, v1
    s_nop 0
    s_cmp_lg_u32 s3, 0
    s_cbranch_scc1 CPF2_X
    v_min_u32 v2, 9, v0
    s_lshr_b32 s62, s2, 3
    s_mul_i32 s62, s62, 1280
    v_lshl_add_u32 v2, v2, 7, s62
    v_min_u32 v2, TEXT_END-CPF2-4, v2
    s_getpc_b64 s[62:63]
CPF2:
    v_mov_b32 v3, s63
    v_add_co_u32 v2, vcc, s62, v2
    s_nop 1
    v_addc_co_u32 v3, vcc, 0, v3, vcc
    global_load_dword v25, v[2:3], off
CPF2_X:
    s_and_b32 s16, s2, 7
    s_lshr_b32 s17, s2, 3
    s_lshr_b32 s18, s16, 2
    s_lshl_b32 s18, s18, 3
    s_and_b32 s19, s17, 7
    s_add_u32 s18, s18, s19
    s_and_b32 s19, s16, 3
    s_lshl_b32 s19, s19, 2
    s_lshr_b32 s20, s17, 3
    s_add_u32 s19, s19, s20
    s_and_b32 s21, s3, 3
    s_lshr_b32 s22, s3, 2
    s_lshl_b32 s24, s18, 3
    s_add_u32 s24, s24, s3
    s_lshl_b32 s24, s24, 15
    s_mul_i32 s25, s3, 49152
    s_lshl_b32 s26, s19, 7
    s_add_u32 s25, s25, s26
    s_lshl_b32 s26, s3, 11
    s_mul_i32 s27, s3, 3072
    s_add_u32 s27, s27, 16384
    v_lshlrev_b32 v1, 4, v0
    v_lshrrev_b32 v8, 3, v0
    v_and_b32 v9, 7, v0
    v_xor_b32 v9, v9, v8
    v_lshlrev_b32 v9, 4, v9
    v_lshl_add_u32 v5, v8, 11, v9
    v_add_u32 v6, 15360, v5
    s_movk_i32 s28, 6144
    v_mul_lo_u32 v10, v8, s28
    v_bfe_u32 v7, v0, 4, 1
    s_and_b32 s29, s3, 1
    s_lshl_b32 s29, s29, 1
    v_or_b32 v7, s29, v7
    v_bfe_u32 v8, v0, 1, 2
    v_xor_b32 v7, v7, v8
    v_lshlrev_b32 v7, 5, v7
    v_and_b32 v8, 1, v0
    v_lshl_add_u32 v7, v8, 4, v7
    v_add_u32 v10, v10, v7
    v_add_u32 v2, 0, v10
    v_add_u32 v3, 1024, v10
    v_add_u32 v4, 2048, v10
    s_waitcnt lgkmcnt(0)
    s_mov_b32 s4, s40
    s_mov_b32 s5, s41
    s_mov_b32 s6, 0x600000
    s_mov_b32 s7, 0x00020000
    s_mov_b32 s8, s42
    s_mov_b32 s9, s43
    s_mov_b32 s10, 0x10000000
    s_mov_b32 s11, 0x00020000
    s_mov_b32 s12, s44
    s_mov_b32 s13, s45
    s_mov_b32 s14, 0x400000
    s_mov_b32 s15, 0x00020000
    s_add_u32 m0, s26, 0
    s_nop 0
    buffer_load_dwordx4 v5, s[12:15], s24 offen offset:0 lds
    buffer_load_dwordx4 v6, s[12:15], s24 offen offset:1024 lds
    s_add_u32 s24, s24, 128
    s_add_u32 m0, s27, 0
    s_nop 0
    buffer_load_dwordx4 v2, s[4:7], s25 offen offset:0 lds
    buffer_load_dwordx4 v3, s[4:7], s25 offen offset:1024 lds
    buffer_load_dwordx4 v4, s[4:7], s25 offen offset:2048 lds
    s_add_u32 s25, s25, 393216
    v_and_b32 v28, 15, v0
    v_lshrrev_b32 v29, 4, v0
    v_and_b32 v30, 7, v0
    v_xor_b32 v30, v30, v29
    v_lshlrev_b32 v30, 4, v30
    v_lshl_add_u32 v30, v28, 7, v30
    s_lshl_b32 s29, s21, 12
    s_lshl_b32 s31, s22, 11
    s_add_u32 s29, s29, s31
    v_add_u32 v7, s29, v30
    v_xor_b32 v8, 2048, v7
    v_xor_b32 v9, 64, v7
    v_xor_b32 v10, 64, v8
    v_add_u32 v11, 40960, v7
    v_add_u32 v12, 40960, v8
    v_add_u32 v13, 40960, v9
    v_add_u32 v14, 40960, v10
    v_add_u32 v15, 81920, v7
    v_add_u32 v16, 81920, v8
    v_add_u32 v17, 81920, v9
    v_add_u32 v18, 81920, v10
    v_lshrrev_b32 v28, 4, v0
    v_mul_u32_u24 v29, 3072, v28
    v_bfe_u32 v30, v0, 2, 2
    v_lshl_add_u32 v29, v30, 7, v29
    v_and_b32 v31, 3, v0
    v_lshl_add_u32 v29, v31, 3, v29
    v_lshrrev_b32 v30, 1, v30
    v_and_b32 v28, 1, v28
    v_lshl_add_u32 v30, v28, 1, v30
    s_lshl_b32 s29, s22, 1
    v_xor_b32 v31, s29, v30
    v_lshl_add_u32 v19, v31, 5, v29
    v_add_u32 v19, 16384, v19
    v_add_u32 v21, 40960, v19
    v_add_u32 v23, 81920, v19
    v_xor_b32 v31, s29, v30
    v_xor_b32 v31, 1, v31
    v_lshl_add_u32 v20, v31, 5, v29
    v_add_u32 v20, 16384, v20
    v_add_u32 v22, 40960, v20
    v_add_u32 v24, 81920, v20
    s_barrier
    s_add_u32 m0, s26, 40960
    s_nop 0
    buffer_load_dwordx4 v5, s[12:15], s24 offen offset:0 lds
    buffer_load_dwordx4 v6, s[12:15], s24 offen offset:1024 lds
    s_add_u32 s24, s24, 128
    s_add_u32 m0, s27, 40960
    s_nop 0
    buffer_load_dwordx4 v2, s[4:7], s25 offen offset:0 lds
    buffer_load_dwordx4 v3, s[4:7], s25 offen offset:1024 lds
    buffer_load_dwordx4 v4, s[4:7], s25 offen offset:2048 lds
    s_add_u32 s25, s25, 393216
    s_cmp_lt_u32 s3, 2
    s_cbranch_scc1 K1_PFX
    s_sub_u32 s29, s3, 2
    s_and_b32 s31, s29, 1
    s_mul_i32 s31, s31, 28
    v_add_u32 v26, s31, v0
    v_lshlrev_b32 v26, 4, v26
    s_add_u32 s31, s18, 128
    v_add_u32 v26, s31, v26
    v_mul_u32_u24 v26, 6144, v26
    s_lshr_b32 s29, s29, 1
    s_lshl_b32 s29, s29, 11
    s_lshl_b32 s31, s19, 7
    s_add_u32 s29, s29, s31
    v_cmp_gt_u32 vcc, 28, v0
    s_mov_b64 s[44:45], s[4:5]
    s_mov_b32 s46, s6
    s_branch K1_PFG
K1_PFX:
    v_and_b32 v26, 7, v0
    v_lshlrev_b32 v26, 11, v26
    v_lshrrev_b32 v27, 3, v0
    v_lshl_add_u32 v26, v27, 7, v26
    s_lshl_b32 s29, s18, 4
    s_add_u32 s29, s29, s19
    s_lshl_b32 s29, s29, 14
    s_mul_i32 s31, s3, 7
    s_add_u32 s31, s31, 2
    s_lshl_b32 s31, s31, 7
    s_add_u32 s29, s29, s31
    v_cmp_gt_u32 vcc, 56, v0
    s_mov_b64 s[44:45], s[12:13]
    s_mov_b32 s46, s14
K1_PFG:
    s_mov_b32 s47, 0x00020000
    v_mov_b32 v27, 0x7fff0000
    v_cndmask_b32 v26, v27, v26, vcc
    buffer_load_dword v27, v26, s[44:47], s29 offen
    s_lshr_b32 s23, s21, 1
    s_and_b32 s29, s21, 1
    s_cmp_lg_u32 s29, 0
    s_cselect_b64 vcc, -1, 0
    v_mov_b64 v[32:33], 0
    v_mov_b64 v[34:35], 0
    v_mov_b64 v[36:37], 0
    v_mov_b64 v[38:39], 0
    v_mov_b64 v[40:41], 0
    v_mov_b64 v[42:43], 0
    v_mov_b64 v[44:45], 0
    v_mov_b64 v[46:47], 0
    v_mov_b64 v[48:49], 0
    v_mov_b64 v[50:51], 0
    v_mov_b64 v[52:53], 0
    v_mov_b64 v[54:55], 0
    v_mov_b64 v[56:57], 0
    v_mov_b64 v[58:59], 0
    v_mov_b64 v[60:61], 0
    v_mov_b64 v[62:63], 0
    v_mov_b64 v[64:65], 0
    v_mov_b64 v[66:67], 0
    v_mov_b64 v[68:69], 0
    v_mov_b64 v[70:71], 0
    v_mov_b64 v[72:73], 0
    v_mov_b64 v[74:75], 0
    v_mov_b64 v[76:77], 0
    v_mov_b64 v[78:79], 0
    s_mov_b32 s50, s29
    v_mov_b64 v[144:145], 0
    v_mov_b64 v[146:147], 0
    v_mov_b64 v[148:149], 0
    v_mov_b64 v[150:151], 0
    v_lshrrev_b32 v156, 4, v0
    v_xor_b32 v156, v156, v0
    v_and_b32 v156, 2, v156
    v_cmp_eq_u32 s[40:41], 0, v156
    v_mov_b32 v152, 0x3f803f80
    s_nop 0
    v_cndmask_b32 v156, 0, v152, s[40:41]
    v_cndmask_b32 v157, 0, v152, s[40:41]
    v_cndmask_b32 v158, 0, v152, s[40:41]
    v_cndmask_b32 v159, 0, v152, s[40:41]
    v_and_b32 v152, 1, v0
    v_mul_u32_u24 v152, 0xaa, v152
    v_add_u32 v152, 0x44, v152
    v_perm_b32 v152, v152, v152, 0
    v_mov_b64 v[160:161], 0
    v_mov_b64 v[162:163], 0
    v_mov_b64 v[164:165], 0
    v_mov_b64 v[166:167], 0
    v_lshrrev_b32 v28, 4, v0
    v_and_b32 v29, 15, v0
    v_lshlrev_b32 v30, 4, v28
    s_lshl_b32 s29, s22, 10
    s_add_u32 s29, s29, 122880
    s_and_b32 s31, s21, 1
    s_lshl_b32 s32, s31, 8
    s_lshl_b32 s33, s23, 6
    s_add_u32 s32, s32, s33
    s_add_u32 s32, s32, s29
    v_lshl_add_u32 v168, v29, 2, s32
    s_lshl_b32 s32, s21, 6
    s_add_u32 s32, s32, s29
    v_lshl_add_u32 v175, v29, 2, s32
    s_lshl_b32 s31, s19, 1
    s_add_u32 s31, s31, s22
    s_lshl_b32 s32, s18, 3
    s_lshl_b32 s33, s21, 1
    s_add_u32 s32, s32, s33
    s_lshl_b32 s33, s31, 7
    s_add_u32 s33, s33, s32
    s_lshl_b32 s33, s33, 10
    s_add_u32 s33, s33, 4194304
    s_lshl_b32 s34, s31, 6
    s_lshr_b32 s35, s32, 1
    s_add_u32 s34, s34, s35
    s_lshl_b32 s34, s34, 12
    s_add_u32 s34, s34, 8388608
    s_lshl_b32 s35, s22, 10
    s_xor_b32 s36, s35, 1024
    s_add_u32 s37, s33, s35
    s_add_u32 s38, s33, s36
    s_add_u32 s39, s34, s35
    s_add_u32 s48, s34, s36
    s_mul_i32 s29, s22, 1024
    s_add_u32 s29, s29, 122880
    v_add_u32 v169, s29, v30
    v_lshl_add_u32 v170, v29, 2, s29
    s_lshl_b32 s29, s21, 7
    s_lshl_b32 s31, s22, 6
    s_add_u32 s29, s29, s31
    s_add_u32 s29, s29, 124928
    v_lshl_add_u32 v171, v29, 2, s29
    v_add_u32 v172, s29, v30
    v_xor_b32 v173, 64, v171
    v_xor_b32 v174, 64, v172
    s_waitcnt vmcnt(6)
    s_barrier
    ds_read_b128 v[128:131], v7
    ds_read_b128 v[136:139], v8
    ds_read_b64_tr_b16 v[80:81], v19 offset:0
    ds_read_b64_tr_b16 v[82:83], v19 offset:512
    ds_read_b64_tr_b16 v[84:85], v20 offset:0
    ds_read_b64_tr_b16 v[86:87], v20 offset:512
    ds_read_b64_tr_b16 v[88:89], v19 offset:1024
    ds_read_b64_tr_b16 v[90:91], v19 offset:1536
    ds_read_b64_tr_b16 v[92:93], v20 offset:1024
    ds_read_b64_tr_b16 v[94:95], v20 offset:1536
    ds_read_b64_tr_b16 v[96:97], v19 offset:2048
    ds_read_b64_tr_b16 v[98:99], v19 offset:2560
    ds_read_b64_tr_b16 v[100:101], v20 offset:2048
    ds_read_b64_tr_b16 v[102:103], v20 offset:2560
    s_add_u32 m0, s26, 81920
    s_nop 0
    buffer_load_dwordx4 v5, s[12:15], s24 offen offset:0 lds
    buffer_load_dwordx4 v6, s[12:15], s24 offen offset:1024 lds
    s_add_u32 s24, s24, 128
    s_add_u32 m0, s27, 81920
    s_nop 0
    buffer_load_dwordx4 v2, s[4:7], s25 offen offset:0 lds
    buffer_load_dwordx4 v3, s[4:7], s25 offen offset:1024 lds
    buffer_load_dwordx4 v4, s[4:7], s25 offen offset:2048 lds
    s_add_u32 s25, s25, 393216
    s_mov_b32 s30, 4
L_k1_loop:
    s_waitcnt lgkmcnt(0)
    v_mfma_f32_16x16x32_bf16 v[32:35], v[80:83], v[128:131], v[32:35]
    ds_read_b128 v[132:135], v9
    ds_read_b128 v[140:143], v10
    v_mfma_f32_16x16x32_bf16 v[36:39], v[80:83], v[136:139], v[36:39]
    ds_read_b64_tr_b16 v[104:105], v19 offset:12288
    v_mfma_f32_16x16x32_bf16 v[40:43], v[84:87], v[128:131], v[40:43]
    ds_read_b64_tr_b16 v[106:107], v19 offset:12800
    v_mfma_f32_16x16x32_bf16 v[44:47], v[84:87], v[136:139], v[44:47]
    ds_read_b64_tr_b16 v[108:109], v20 offset:12288
    v_mfma_f32_16x16x32_bf16 v[160:163], v[128:131], v[128:131], v[160:163]
    ds_read_b64_tr_b16 v[110:111], v20 offset:12800
    ds_read_b64_tr_b16 v[112:113], v19 offset:13312
    v_mfma_f32_16x16x32_bf16 v[48:51], v[88:91], v[128:131], v[48:51]
    ds_read_b64_tr_b16 v[114:115], v19 offset:13824
    v_mfma_f32_16x16x32_bf16 v[52:55], v[88:91], v[136:139], v[52:55]
    ds_read_b64_tr_b16 v[116:117], v20 offset:13312
    v_mfma_f32_16x16x32_bf16 v[56:59], v[92:95], v[128:131], v[56:59]
    ds_read_b64_tr_b16 v[118:119], v20 offset:13824
    v_mfma_f32_16x16x32_bf16 v[60:63], v[92:95], v[136:139], v[60:63]
    ds_read_b64_tr_b16 v[120:121], v19 offset:14336
    ds_read_b64_tr_b16 v[122:123], v19 offset:14848
    v_mfma_f32_16x16x32_bf16 v[64:67], v[128:131], v[96:99], v[64:67]
    ds_read_b64_tr_b16 v[124:125], v20 offset:14336
    v_mfma_f32_16x16x32_bf16 v[68:71], v[136:139], v[96:99], v[68:71]
    ds_read_b64_tr_b16 v[126:127], v20 offset:14848
    v_mfma_f32_16x16x32_bf16 v[72:75], v[128:131], v[100:103], v[72:75]
    v_mfma_f32_16x16x32_bf16 v[76:79], v[136:139], v[100:103], v[76:79]
    s_cmp_lg_u32 s23, 0
    s_cbranch_scc1 K1_CE0
    s_cbranch_vccnz K1_CB0
    v_smfmac_f32_16x16x64_bf16 v[144:147], v[156:159], v[80:87], v152
    s_branch K1_CC0
K1_CB0:
    v_smfmac_f32_16x16x64_bf16 v[144:147], v[156:159], v[88:95], v152
K1_CC0:
    s_xor_b32 s50, s50, 1
    s_cbranch_scc0 K1_CE0
    v_smfmac_f32_16x16x64_bf16 v[148:151], v[156:159], v[96:103], v152
K1_CE0:
    s_cmp_eq_u32 s30, 4
    s_cbranch_scc1 L_k1_vf0
    s_waitcnt vmcnt(5)
L_k1_vf0:
    s_waitcnt vmcnt(6) lgkmcnt(0)
    s_barrier
    v_smfmac_f32_16x16x64_bf16 v[164:167], v[156:159], v[128:135], v152
    ds_read_b128 v[128:131], v11
    ds_read_b128 v[136:139], v12
    v_mfma_f32_16x16x32_bf16 v[32:35], v[104:107], v[132:135], v[32:35]
    ds_read_b64_tr_b16 v[80:81], v21 offset:0
    s_add_u32 m0, s26, 0
    v_mfma_f32_16x16x32_bf16 v[36:39], v[104:107], v[140:143], v[36:39]
    ds_read_b64_tr_b16 v[82:83], v21 offset:512
    buffer_load_dwordx4 v5, s[12:15], s24 offen offset:0 lds
    v_mfma_f32_16x16x32_bf16 v[40:43], v[108:111], v[132:135], v[40:43]
    ds_read_b64_tr_b16 v[84:85], v22 offset:0
    v_mfma_f32_16x16x32_bf16 v[44:47], v[108:111], v[140:143], v[44:47]
    ds_read_b64_tr_b16 v[86:87], v22 offset:512
    buffer_load_dwordx4 v6, s[12:15], s24 offen offset:1024 lds
    s_add_u32 s24, s24, 128
    v_mfma_f32_16x16x32_bf16 v[160:163], v[132:135], v[132:135], v[160:163]
    ds_read_b64_tr_b16 v[88:89], v21 offset:1024
    s_add_u32 m0, s27, 0
    v_mfma_f32_16x16x32_bf16 v[48:51], v[112:115], v[132:135], v[48:51]
    ds_read_b64_tr_b16 v[90:91], v21 offset:1536
    buffer_load_dwordx4 v2, s[4:7], s25 offen offset:0 lds
    v_mfma_f32_16x16x32_bf16 v[52:55], v[112:115], v[140:143], v[52:55]
    ds_read_b64_tr_b16 v[92:93], v22 offset:1024
    ds_read_b64_tr_b16 v[94:95], v22 offset:1536
    v_mfma_f32_16x16x32_bf16 v[56:59], v[116:119], v[132:135], v[56:59]
    ds_read_b64_tr_b16 v[96:97], v21 offset:2048
    buffer_load_dwordx4 v3, s[4:7], s25 offen offset:1024 lds
    v_mfma_f32_16x16x32_bf16 v[60:63], v[116:119], v[140:143], v[60:63]
    ds_read_b64_tr_b16 v[98:99], v21 offset:2560
    v_mfma_f32_16x16x32_bf16 v[64:67], v[132:135], v[120:123], v[64:67]
    ds_read_b64_tr_b16 v[100:101], v22 offset:2048
    buffer_load_dwordx4 v4, s[4:7], s25 offen offset:2048 lds
    s_add_u32 s25, s25, 393216
    v_mfma_f32_16x16x32_bf16 v[68:71], v[140:143], v[120:123], v[68:71]
    ds_read_b64_tr_b16 v[102:103], v22 offset:2560
    v_mfma_f32_16x16x32_bf16 v[72:75], v[132:135], v[124:127], v[72:75]
    v_mfma_f32_16x16x32_bf16 v[76:79], v[140:143], v[124:127], v[76:79]
    s_cmp_lg_u32 s23, 1
    s_cbranch_scc1 K1_CE1
    s_cbranch_vccnz K1_CB1
    v_smfmac_f32_16x16x64_bf16 v[144:147], v[156:159], v[104:111], v152
    s_branch K1_CC1
K1_CB1:
    v_smfmac_f32_16x16x64_bf16 v[144:147], v[156:159], v[112:119], v152
K1_CC1:
    s_xor_b32 s50, s50, 1
    s_cbranch_scc0 K1_CE1
    v_smfmac_f32_16x16x64_bf16 v[148:151], v[156:159], v[120:127], v152
K1_CE1:
    s_waitcnt lgkmcnt(0)
    v_mfma_f32_16x16x32_bf16 v[32:35], v[80:83], v[128:131], v[32:35]
    ds_read_b128 v[132:135], v13
    ds_read_b128 v[140:143], v14
    v_mfma_f32_16x16x32_bf16 v[36:39], v[80:83], v[136:139], v[36:39]
    ds_read_b64_tr_b16 v[104:105], v21 offset:12288
    v_mfma_f32_16x16x32_bf16 v[40:43], v[84:87], v[128:131], v[40:43]
    ds_read_b64_tr_b16 v[106:107], v21 offset:12800
    v_mfma_f32_16x16x32_bf16 v[44:47], v[84:87], v[136:139], v[44:47]
    ds_read_b64_tr_b16 v[108:109], v22 offset:12288
    v_mfma_f32_16x16x32_bf16 v[160:163], v[128:131], v[128:131], v[160:163]
    ds_read_b64_tr_b16 v[110:111], v22 offset:12800
    ds_read_b64_tr_b16 v[112:113], v21 offset:13312
    v_mfma_f32_16x16x32_bf16 v[48:51], v[88:91], v[128:131], v[48:51]
    ds_read_b64_tr_b16 v[114:115], v21 offset:13824
    v_mfma_f32_16x16x32_bf16 v[52:55], v[88:91], v[136:139], v[52:55]
    ds_read_b64_tr_b16 v[116:117], v22 offset:13312
    v_mfma_f32_16x16x32_bf16 v[56:59], v[92:95], v[128:131], v[56:59]
    ds_read_b64_tr_b16 v[118:119], v22 offset:13824
    v_mfma_f32_16x16x32_bf16 v[60:63], v[92:95], v[136:139], v[60:63]
    ds_read_b64_tr_b16 v[120:121], v21 offset:14336
    ds_read_b64_tr_b16 v[122:123], v21 offset:14848
    v_mfma_f32_16x16x32_bf16 v[64:67], v[128:131], v[96:99], v[64:67]
    ds_read_b64_tr_b16 v[124:125], v22 offset:14336
    v_mfma_f32_16x16x32_bf16 v[68:71], v[136:139], v[96:99], v[68:71]
    ds_read_b64_tr_b16 v[126:127], v22 offset:14848
    v_mfma_f32_16x16x32_bf16 v[72:75], v[128:131], v[100:103], v[72:75]
    v_mfma_f32_16x16x32_bf16 v[76:79], v[136:139], v[100:103], v[76:79]
    s_cmp_lg_u32 s23, 0
    s_cbranch_scc1 K1_CE2
    s_cbranch_vccnz K1_CB2
    v_smfmac_f32_16x16x64_bf16 v[144:147], v[156:159], v[80:87], v152
    s_branch K1_CC2
K1_CB2:
    v_smfmac_f32_16x16x64_bf16 v[144:147], v[156:159], v[88:95], v152
K1_CC2:
    s_xor_b32 s50, s50, 1
    s_cbranch_scc0 K1_CE2
    v_smfmac_f32_16x16x64_bf16 v[148:151], v[156:159], v[96:103], v152
K1_CE2:
    s_waitcnt vmcnt(5) lgkmcnt(0)
    s_barrier
    v_smfmac_f32_16x16x64_bf16 v[164:167], v[156:159], v[128:135], v152
    ds_read_b128 v[128:131], v15
    ds_read_b128 v[136:139], v16
    v_mfma_f32_16x16x32_bf16 v[32:35], v[104:107], v[132:135], v[32:35]
    ds_read_b64_tr_b16 v[80:81], v23 offset:0
    s_add_u32 m0, s26, 40960
    v_mfma_f32_16x16x32_bf16 v[36:39], v[104:107], v[140:143], v[36:39]
    ds_read_b64_tr_b16 v[82:83], v23 offset:512
    buffer_load_dwordx4 v5, s[12:15], s24 offen offset:0 lds
    v_mfma_f32_16x16x32_bf16 v[40:43], v[108:111], v[132:135], v[40:43]
    ds_read_b64_tr_b16 v[84:85], v24 offset:0
    v_mfma_f32_16x16x32_bf16 v[44:47], v[108:111], v[140:143], v[44:47]
    ds_read_b64_tr_b16 v[86:87], v24 offset:512
    buffer_load_dwordx4 v6, s[12:15], s24 offen offset:1024 lds
    s_add_u32 s24, s24, 128
    v_mfma_f32_16x16x32_bf16 v[160:163], v[132:135], v[132:135], v[160:163]
    ds_read_b64_tr_b16 v[88:89], v23 offset:1024
    s_add_u32 m0, s27, 40960
    v_mfma_f32_16x16x32_bf16 v[48:51], v[112:115], v[132:135], v[48:51]
    ds_read_b64_tr_b16 v[90:91], v23 offset:1536
    buffer_load_dwordx4 v2, s[4:7], s25 offen offset:0 lds
    v_mfma_f32_16x16x32_bf16 v[52:55], v[112:115], v[140:143], v[52:55]
    ds_read_b64_tr_b16 v[92:93], v24 offset:1024
    ds_read_b64_tr_b16 v[94:95], v24 offset:1536
    v_mfma_f32_16x16x32_bf16 v[56:59], v[116:119], v[132:135], v[56:59]
    ds_read_b64_tr_b16 v[96:97], v23 offset:2048
    buffer_load_dwordx4 v3, s[4:7], s25 offen offset:1024 lds
    v_mfma_f32_16x16x32_bf16 v[60:63], v[116:119], v[140:143], v[60:63]
    ds_read_b64_tr_b16 v[98:99], v23 offset:2560
    v_mfma_f32_16x16x32_bf16 v[64:67], v[132:135], v[120:123], v[64:67]
    ds_read_b64_tr_b16 v[100:101], v24 offset:2048
    buffer_load_dwordx4 v4, s[4:7], s25 offen offset:2048 lds
    s_add_u32 s25, s25, 393216
    v_mfma_f32_16x16x32_bf16 v[68:71], v[140:143], v[120:123], v[68:71]
    ds_read_b64_tr_b16 v[102:103], v24 offset:2560
    v_mfma_f32_16x16x32_bf16 v[72:75], v[132:135], v[124:127], v[72:75]
    v_mfma_f32_16x16x32_bf16 v[76:79], v[140:143], v[124:127], v[76:79]
    s_cmp_lg_u32 s23, 1
    s_cbranch_scc1 K1_CE3
    s_cbranch_vccnz K1_CB3
    v_smfmac_f32_16x16x64_bf16 v[144:147], v[156:159], v[104:111], v152
    s_branch K1_CC3
K1_CB3:
    v_smfmac_f32_16x16x64_bf16 v[144:147], v[156:159], v[112:119], v152
K1_CC3:
    s_xor_b32 s50, s50, 1
    s_cbranch_scc0 K1_CE3
    v_smfmac_f32_16x16x64_bf16 v[148:151], v[156:159], v[120:127], v152
K1_CE3:
    s_waitcnt lgkmcnt(0)
    v_mfma_f32_16x16x32_bf16 v[32:35], v[80:83], v[128:131], v[32:35]
    ds_read_b128 v[132:135], v17
    ds_read_b128 v[140:143], v18
    v_mfma_f32_16x16x32_bf16 v[36:39], v[80:83], v[136:139], v[36:39]
    ds_read_b64_tr_b16 v[104:105], v23 offset:12288
    v_mfma_f32_16x16x32_bf16 v[40:43], v[84:87], v[128:131], v[40:43]
    ds_read_b64_tr_b16 v[106:107], v23 offset:12800
    v_mfma_f32_16x16x32_bf16 v[44:47], v[84:87], v[136:139], v[44:47]
    ds_read_b64_tr_b16 v[108:109], v24 offset:12288
    v_mfma_f32_16x16x32_bf16 v[160:163], v[128:131], v[128:131], v[160:163]
    ds_read_b64_tr_b16 v[110:111], v24 offset:12800
    ds_read_b64_tr_b16 v[112:113], v23 offset:13312
    v_mfma_f32_16x16x32_bf16 v[48:51], v[88:91], v[128:131], v[48:51]
    ds_read_b64_tr_b16 v[114:115], v23 offset:13824
    v_mfma_f32_16x16x32_bf16 v[52:55], v[88:91], v[136:139], v[52:55]
    ds_read_b64_tr_b16 v[116:117], v24 offset:13312
    v_mfma_f32_16x16x32_bf16 v[56:59], v[92:95], v[128:131], v[56:59]
    ds_read_b64_tr_b16 v[118:119], v24 offset:13824
    v_mfma_f32_16x16x32_bf16 v[60:63], v[92:95], v[136:139], v[60:63]
    ds_read_b64_tr_b16 v[120:121], v23 offset:14336
    ds_read_b64_tr_b16 v[122:123], v23 offset:14848
    v_mfma_f32_16x16x32_bf16 v[64:67], v[128:131], v[96:99], v[64:67]
    ds_read_b64_tr_b16 v[124:125], v24 offset:14336
    v_mfma_f32_16x16x32_bf16 v[68:71], v[136:139], v[96:99], v[68:71]
    ds_read_b64_tr_b16 v[126:127], v24 offset:14848
    v_mfma_f32_16x16x32_bf16 v[72:75], v[128:131], v[100:103], v[72:75]
    v_mfma_f32_16x16x32_bf16 v[76:79], v[136:139], v[100:103], v[76:79]
    s_cmp_lg_u32 s23, 0
    s_cbranch_scc1 K1_CE4
    s_cbranch_vccnz K1_CB4
    v_smfmac_f32_16x16x64_bf16 v[144:147], v[156:159], v[80:87], v152
    s_branch K1_CC4
K1_CB4:
    v_smfmac_f32_16x16x64_bf16 v[144:147], v[156:159], v[88:95], v152
K1_CC4:
    s_xor_b32 s50, s50, 1
    s_cbranch_scc0 K1_CE4
    v_smfmac_f32_16x16x64_bf16 v[148:151], v[156:159], v[96:103], v152
K1_CE4:
    s_waitcnt vmcnt(5) lgkmcnt(0)
    s_barrier
    v_smfmac_f32_16x16x64_bf16 v[164:167], v[156:159], v[128:135], v152
    ds_read_b128 v[128:131], v7
    ds_read_b128 v[136:139], v8
    v_mfma_f32_16x16x32_bf16 v[32:35], v[104:107], v[132:135], v[32:35]
    ds_read_b64_tr_b16 v[80:81], v19 offset:0
    s_add_u32 m0, s26, 81920
    v_mfma_f32_16x16x32_bf16 v[36:39], v[104:107], v[140:143], v[36:39]
    ds_read_b64_tr_b16 v[82:83], v19 offset:512
    buffer_load_dwordx4 v5, s[12:15], s24 offen offset:0 lds
    v_mfma_f32_16x16x32_bf16 v[40:43], v[108:111], v[132:135], v[40:43]
    ds_read_b64_tr_b16 v[84:85], v20 offset:0
    v_mfma_f32_16x16x32_bf16 v[44:47], v[108:111], v[140:143], v[44:47]
    ds_read_b64_tr_b16 v[86:87], v20 offset:512
    buffer_load_dwordx4 v6, s[12:15], s24 offen offset:1024 lds
    s_add_u32 s24, s24, 128
    v_mfma_f32_16x16x32_bf16 v[160:163], v[132:135], v[132:135], v[160:163]
    ds_read_b64_tr_b16 v[88:89], v19 offset:1024
    s_add_u32 m0, s27, 81920
    v_mfma_f32_16x16x32_bf16 v[48:51], v[112:115], v[132:135], v[48:51]
    ds_read_b64_tr_b16 v[90:91], v19 offset:1536
    buffer_load_dwordx4 v2, s[4:7], s25 offen offset:0 lds
    v_mfma_f32_16x16x32_bf16 v[52:55], v[112:115], v[140:143], v[52:55]
    ds_read_b64_tr_b16 v[92:93], v20 offset:1024
    ds_read_b64_tr_b16 v[94:95], v20 offset:1536
    v_mfma_f32_16x16x32_bf16 v[56:59], v[116:119], v[132:135], v[56:59]
    ds_read_b64_tr_b16 v[96:97], v19 offset:2048
    buffer_load_dwordx4 v3, s[4:7], s25 offen offset:1024 lds
    v_mfma_f32_16x16x32_bf16 v[60:63], v[116:119], v[140:143], v[60:63]
    ds_read_b64_tr_b16 v[98:99], v19 offset:2560
    v_mfma_f32_16x16x32_bf16 v[64:67], v[132:135], v[120:123], v[64:67]
    ds_read_b64_tr_b16 v[100:101], v20 offset:2048
    buffer_load_dwordx4 v4, s[4:7], s25 offen offset:2048 lds
    s_add_u32 s25, s25, 393216
    v_mfma_f32_16x16x32_bf16 v[68:71], v[140:143], v[120:123], v[68:71]
    ds_read_b64_tr_b16 v[102:103], v20 offset:2560
    v_mfma_f32_16x16x32_bf16 v[72:75], v[132:135], v[124:127], v[72:75]
    v_mfma_f32_16x16x32_bf16 v[76:79], v[140:143], v[124:127], v[76:79]
    s_cmp_lg_u32 s23, 1
    s_cbranch_scc1 K1_CE5
    s_cbranch_vccnz K1_CB5
    v_smfmac_f32_16x16x64_bf16 v[144:147], v[156:159], v[104:111], v152
    s_branch K1_CC5
K1_CB5:
    v_smfmac_f32_16x16x64_bf16 v[144:147], v[156:159], v[112:119], v152
K1_CC5:
    s_xor_b32 s50, s50, 1
    s_cbranch_scc0 K1_CE5
    v_smfmac_f32_16x16x64_bf16 v[148:151], v[156:159], v[120:127], v152
K1_CE5:
    s_sub_u32 s30, s30, 1
    s_cmp_lg_u32 s30, 0
    s_cbranch_scc1 L_k1_loop
    s_waitcnt lgkmcnt(0)
    v_mfma_f32_16x16x32_bf16 v[32:35], v[80:83], v[128:131], v[32:35]
    ds_read_b128 v[132:135], v9
    ds_read_b128 v[140:143], v10
    v_mfma_f32_16x16x32_bf16 v[36:39], v[80:83], v[136:139], v[36:39]
    ds_read_b64_tr_b16 v[104:105], v19 offset:12288
    v_mfma_f32_16x16x32_bf16 v[40:43], v[84:87], v[128:131], v[40:43]
    ds_read_b64_tr_b16 v[106:107], v19 offset:12800
    v_mfma_f32_16x16x32_bf16 v[44:47], v[84:87], v[136:139], v[44:47]
    ds_read_b64_tr_b16 v[108:109], v20 offset:12288
    v_mfma_f32_16x16x32_bf16 v[160:163], v[128:131], v[128:131], v[160:163]
    ds_read_b64_tr_b16 v[110:111], v20 offset:12800
    ds_read_b64_tr_b16 v[112:113], v19 offset:13312
    v_mfma_f32_16x16x32_bf16 v[48:51], v[88:91], v[128:131], v[48:51]
    ds_read_b64_tr_b16 v[114:115], v19 offset:13824
    v_mfma_f32_16x16x32_bf16 v[52:55], v[88:91], v[136:139], v[52:55]
    ds_read_b64_tr_b16 v[116:117], v20 offset:13312
    v_mfma_f32_16x16x32_bf16 v[56:59], v[92:95], v[128:131], v[56:59]
    ds_read_b64_tr_b16 v[118:119], v20 offset:13824
    v_mfma_f32_16x16x32_bf16 v[60:63], v[92:95], v[136:139], v[60:63]
    ds_read_b64_tr_b16 v[120:121], v19 offset:14336
    ds_read_b64_tr_b16 v[122:123], v19 offset:14848
    v_mfma_f32_16x16x32_bf16 v[64:67], v[128:131], v[96:99], v[64:67]
    ds_read_b64_tr_b16 v[124:125], v20 offset:14336
    v_mfma_f32_16x16x32_bf16 v[68:71], v[136:139], v[96:99], v[68:71]
    ds_read_b64_tr_b16 v[126:127], v20 offset:14848
    v_mfma_f32_16x16x32_bf16 v[72:75], v[128:131], v[100:103], v[72:75]
    v_mfma_f32_16x16x32_bf16 v[76:79], v[136:139], v[100:103], v[76:79]
    s_cmp_lg_u32 s23, 0
    s_cbranch_scc1 K1_CE6
    s_cbranch_vccnz K1_CB6
    v_smfmac_f32_16x16x64_bf16 v[144:147], v[156:159], v[80:87], v152
    s_branch K1_CC6
K1_CB6:
    v_smfmac_f32_16x16x64_bf16 v[144:147], v[156:159], v[88:95], v152
K1_CC6:
    s_xor_b32 s50, s50, 1
    s_cbranch_scc0 K1_CE6
    v_smfmac_f32_16x16x64_bf16 v[148:151], v[156:159], v[96:103], v152
K1_CE6:
    s_waitcnt vmcnt(5) lgkmcnt(0)
    s_barrier
    v_smfmac_f32_16x16x64_bf16 v[164:167], v[156:159], v[128:135], v152
    ds_read_b128 v[128:131], v11
    ds_read_b128 v[136:139], v12
    v_mfma_f32_16x16x32_bf16 v[32:35], v[104:107], v[132:135], v[32:35]
    ds_read_b64_tr_b16 v[80:81], v21 offset:0
    s_add_u32 m0, s26, 0
    v_mfma_f32_16x16x32_bf16 v[36:39], v[104:107], v[140:143], v[36:39]
    ds_read_b64_tr_b16 v[82:83], v21 offset:512
    buffer_load_dwordx4 v5, s[12:15], s24 offen offset:0 lds
    v_mfma_f32_16x16x32_bf16 v[40:43], v[108:111], v[132:135], v[40:43]
    ds_read_b64_tr_b16 v[84:85], v22 offset:0
    v_mfma_f32_16x16x32_bf16 v[44:47], v[108:111], v[140:143], v[44:47]
    ds_read_b64_tr_b16 v[86:87], v22 offset:512
    buffer_load_dwordx4 v6, s[12:15], s24 offen offset:1024 lds
    s_add_u32 s24, s24, 128
    v_mfma_f32_16x16x32_bf16 v[160:163], v[132:135], v[132:135], v[160:163]
    ds_read_b64_tr_b16 v[88:89], v21 offset:1024
    s_add_u32 m0, s27, 0
    v_mfma_f32_16x16x32_bf16 v[48:51], v[112:115], v[132:135], v[48:51]
    ds_read_b64_tr_b16 v[90:91], v21 offset:1536
    buffer_load_dwordx4 v2, s[4:7], s25 offen offset:0 lds
    v_mfma_f32_16x16x32_bf16 v[52:55], v[112:115], v[140:143], v[52:55]
    ds_read_b64_tr_b16 v[92:93], v22 offset:1024
    ds_read_b64_tr_b16 v[94:95], v22 offset:1536
    v_mfma_f32_16x16x32_bf16 v[56:59], v[116:119], v[132:135], v[56:59]
    ds_read_b64_tr_b16 v[96:97], v21 offset:2048
    buffer_load_dwordx4 v3, s[4:7], s25 offen offset:1024 lds
    v_mfma_f32_16x16x32_bf16 v[60:63], v[116:119], v[140:143], v[60:63]
    ds_read_b64_tr_b16 v[98:99], v21 offset:2560
    v_mfma_f32_16x16x32_bf16 v[64:67], v[132:135], v[120:123], v[64:67]
    ds_read_b64_tr_b16 v[100:101], v22 offset:2048
    buffer_load_dwordx4 v4, s[4:7], s25 offen offset:2048 lds
    s_add_u32 s25, s25, 393216
    v_mfma_f32_16x16x32_bf16 v[68:71], v[140:143], v[120:123], v[68:71]
    ds_read_b64_tr_b16 v[102:103], v22 offset:2560
    v_mfma_f32_16x16x32_bf16 v[72:75], v[132:135], v[124:127], v[72:75]
    v_mfma_f32_16x16x32_bf16 v[76:79], v[140:143], v[124:127], v[76:79]
    s_cmp_lg_u32 s23, 1
    s_cbranch_scc1 K1_CE7
    s_cbranch_vccnz K1_CB7
    v_smfmac_f32_16x16x64_bf16 v[144:147], v[156:159], v[104:111], v152
    s_branch K1_CC7
K1_CB7:
    v_smfmac_f32_16x16x64_bf16 v[144:147], v[156:159], v[112:119], v152
K1_CC7:
    s_xor_b32 s50, s50, 1
    s_cbranch_scc0 K1_CE7
    v_smfmac_f32_16x16x64_bf16 v[148:151], v[156:159], v[120:127], v152
K1_CE7:
    s_waitcnt lgkmcnt(0)
    v_mfma_f32_16x16x32_bf16 v[32:35], v[80:83], v[128:131], v[32:35]
    ds_read_b128 v[132:135], v13
    ds_read_b128 v[140:143], v14
    v_mfma_f32_16x16x32_bf16 v[36:39], v[80:83], v[136:139], v[36:39]
    ds_read_b64_tr_b16 v[104:105], v21 offset:12288
    v_mfma_f32_16x16x32_bf16 v[40:43], v[84:87], v[128:131], v[40:43]
    ds_read_b64_tr_b16 v[106:107], v21 offset:12800
    v_mfma_f32_16x16x32_bf16 v[44:47], v[84:87], v[136:139], v[44:47]
    ds_read_b64_tr_b16 v[108:109], v22 offset:12288
    v_mfma_f32_16x16x32_bf16 v[160:163], v[128:131], v[128:131], v[160:163]
    ds_read_b64_tr_b16 v[110:111], v22 offset:12800
    ds_read_b64_tr_b16 v[112:113], v21 offset:13312
    v_mfma_f32_16x16x32_bf16 v[48:51], v[88:91], v[128:131], v[48:51]
    ds_read_b64_tr_b16 v[114:115], v21 offset:13824
    v_mfma_f32_16x16x32_bf16 v[52:55], v[88:91], v[136:139], v[52:55]
    ds_read_b64_tr_b16 v[116:117], v22 offset:13312
    v_mfma_f32_16x16x32_bf16 v[56:59], v[92:95], v[128:131], v[56:59]
    ds_read_b64_tr_b16 v[118:119], v22 offset:13824
    v_mfma_f32_16x16x32_bf16 v[60:63], v[92:95], v[136:139], v[60:63]
    ds_read_b64_tr_b16 v[120:121], v21 offset:14336
    ds_read_b64_tr_b16 v[122:123], v21 offset:14848
    v_mfma_f32_16x16x32_bf16 v[64:67], v[128:131], v[96:99], v[64:67]
    ds_read_b64_tr_b16 v[124:125], v22 offset:14336
    v_mfma_f32_16x16x32_bf16 v[68:71], v[136:139], v[96:99], v[68:71]
    ds_read_b64_tr_b16 v[126:127], v22 offset:14848
    v_mfma_f32_16x16x32_bf16 v[72:75], v[128:131], v[100:103], v[72:75]
    v_mfma_f32_16x16x32_bf16 v[76:79], v[136:139], v[100:103], v[76:79]
    s_cmp_lg_u32 s23, 0
    s_cbranch_scc1 K1_CE8
    s_cbranch_vccnz K1_CB8
    v_smfmac_f32_16x16x64_bf16 v[144:147], v[156:159], v[80:87], v152
    s_branch K1_CC8
K1_CB8:
    v_smfmac_f32_16x16x64_bf16 v[144:147], v[156:159], v[88:95], v152
K1_CC8:
    s_xor_b32 s50, s50, 1
    s_cbranch_scc0 K1_CE8
    v_smfmac_f32_16x16x64_bf16 v[148:151], v[156:159], v[96:103], v152
K1_CE8:
    s_waitcnt vmcnt(5) lgkmcnt(0)
    s_barrier
    v_smfmac_f32_16x16x64_bf16 v[164:167], v[156:159], v[128:135], v152
    ds_read_b128 v[128:131], v15
    ds_read_b128 v[136:139], v16
    v_mfma_f32_16x16x32_bf16 v[32:35], v[104:107], v[132:135], v[32:35]
    ds_read_b64_tr_b16 v[80:81], v23 offset:0
    v_mfma_f32_16x16x32_bf16 v[36:39], v[104:107], v[140:143], v[36:39]
    ds_read_b64_tr_b16 v[82:83], v23 offset:512
    v_mfma_f32_16x16x32_bf16 v[40:43], v[108:111], v[132:135], v[40:43]
    ds_read_b64_tr_b16 v[84:85], v24 offset:0
    v_mfma_f32_16x16x32_bf16 v[44:47], v[108:111], v[140:143], v[44:47]
    ds_read_b64_tr_b16 v[86:87], v24 offset:512
    v_mfma_f32_16x16x32_bf16 v[160:163], v[132:135], v[132:135], v[160:163]
    ds_read_b64_tr_b16 v[88:89], v23 offset:1024
    v_mfma_f32_16x16x32_bf16 v[48:51], v[112:115], v[132:135], v[48:51]
    ds_read_b64_tr_b16 v[90:91], v23 offset:1536
    v_mfma_f32_16x16x32_bf16 v[52:55], v[112:115], v[140:143], v[52:55]
    ds_read_b64_tr_b16 v[92:93], v24 offset:1024
    ds_read_b64_tr_b16 v[94:95], v24 offset:1536
    v_mfma_f32_16x16x32_bf16 v[56:59], v[116:119], v[132:135], v[56:59]
    ds_read_b64_tr_b16 v[96:97], v23 offset:2048
    v_mfma_f32_16x16x32_bf16 v[60:63], v[116:119], v[140:143], v[60:63]
    ds_read_b64_tr_b16 v[98:99], v23 offset:2560
    v_mfma_f32_16x16x32_bf16 v[64:67], v[132:135], v[120:123], v[64:67]
    ds_read_b64_tr_b16 v[100:101], v24 offset:2048
    v_mfma_f32_16x16x32_bf16 v[68:71], v[140:143], v[120:123], v[68:71]
    ds_read_b64_tr_b16 v[102:103], v24 offset:2560
    v_mfma_f32_16x16x32_bf16 v[72:75], v[132:135], v[124:127], v[72:75]
    v_mfma_f32_16x16x32_bf16 v[76:79], v[140:143], v[124:127], v[76:79]
    s_cmp_lg_u32 s23, 1
    s_cbranch_scc1 K1_CE9
    s_cbranch_vccnz K1_CB9
    v_smfmac_f32_16x16x64_bf16 v[144:147], v[156:159], v[104:111], v152
    s_branch K1_CC9
K1_CB9:
    v_smfmac_f32_16x16x64_bf16 v[144:147], v[156:159], v[112:119], v152
K1_CC9:
    s_xor_b32 s50, s50, 1
    s_cbranch_scc0 K1_CE9
    v_smfmac_f32_16x16x64_bf16 v[148:151], v[156:159], v[120:127], v152
K1_CE9:
    s_waitcnt lgkmcnt(0)
    v_mfma_f32_16x16x32_bf16 v[32:35], v[80:83], v[128:131], v[32:35]
    ds_read_b128 v[132:135], v17
    ds_read_b128 v[140:143], v18
    v_mfma_f32_16x16x32_bf16 v[36:39], v[80:83], v[136:139], v[36:39]
    ds_read_b64_tr_b16 v[104:105], v23 offset:12288
    v_mfma_f32_16x16x32_bf16 v[40:43], v[84:87], v[128:131], v[40:43]
    ds_read_b64_tr_b16 v[106:107], v23 offset:12800
    v_mfma_f32_16x16x32_bf16 v[44:47], v[84:87], v[136:139], v[44:47]
    ds_read_b64_tr_b16 v[108:109], v24 offset:12288
    v_mfma_f32_16x16x32_bf16 v[160:163], v[128:131], v[128:131], v[160:163]
    ds_read_b64_tr_b16 v[110:111], v24 offset:12800
    ds_read_b64_tr_b16 v[112:113], v23 offset:13312
    v_mfma_f32_16x16x32_bf16 v[48:51], v[88:91], v[128:131], v[48:51]
    ds_read_b64_tr_b16 v[114:115], v23 offset:13824
    v_mfma_f32_16x16x32_bf16 v[52:55], v[88:91], v[136:139], v[52:55]
    ds_read_b64_tr_b16 v[116:117], v24 offset:13312
    v_mfma_f32_16x16x32_bf16 v[56:59], v[92:95], v[128:131], v[56:59]
    ds_read_b64_tr_b16 v[118:119], v24 offset:13824
    v_mfma_f32_16x16x32_bf16 v[60:63], v[92:95], v[136:139], v[60:63]
    ds_read_b64_tr_b16 v[120:121], v23 offset:14336
    ds_read_b64_tr_b16 v[122:123], v23 offset:14848
    v_mfma_f32_16x16x32_bf16 v[64:67], v[128:131], v[96:99], v[64:67]
    ds_read_b64_tr_b16 v[124:125], v24 offset:14336
    v_mfma_f32_16x16x32_bf16 v[68:71], v[136:139], v[96:99], v[68:71]
    ds_read_b64_tr_b16 v[126:127], v24 offset:14848
    v_mfma_f32_16x16x32_bf16 v[72:75], v[128:131], v[100:103], v[72:75]
    v_mfma_f32_16x16x32_bf16 v[76:79], v[136:139], v[100:103], v[76:79]
    s_cmp_lg_u32 s23, 0
    s_cbranch_scc1 K1_CE10
    s_cbranch_vccnz K1_CB10
    v_smfmac_f32_16x16x64_bf16 v[144:147], v[156:159], v[80:87], v152
    s_branch K1_CC10
K1_CB10:
    v_smfmac_f32_16x16x64_bf16 v[144:147], v[156:159], v[88:95], v152
K1_CC10:
    s_xor_b32 s50, s50, 1
    s_cbranch_scc0 K1_CE10
    v_smfmac_f32_16x16x64_bf16 v[148:151], v[156:159], v[96:103], v152
K1_CE10:
    s_waitcnt vmcnt(0) lgkmcnt(0)
    s_barrier
    v_smfmac_f32_16x16x64_bf16 v[164:167], v[156:159], v[128:135], v152
    ds_read_b128 v[128:131], v7
    ds_read_b128 v[136:139], v8
    v_mfma_f32_16x16x32_bf16 v[32:35], v[104:107], v[132:135], v[32:35]
    ds_read_b64_tr_b16 v[80:81], v19 offset:0
    v_mfma_f32_16x16x32_bf16 v[36:39], v[104:107], v[140:143], v[36:39]
    ds_read_b64_tr_b16 v[82:83], v19 offset:512
    v_mfma_f32_16x16x32_bf16 v[40:43], v[108:111], v[132:135], v[40:43]
    ds_read_b64_tr_b16 v[84:85], v20 offset:0
    v_mfma_f32_16x16x32_bf16 v[44:47], v[108:111], v[140:143], v[44:47]
    ds_read_b64_tr_b16 v[86:87], v20 offset:512
    v_mfma_f32_16x16x32_bf16 v[160:163], v[132:135], v[132:135], v[160:163]
    ds_read_b64_tr_b16 v[88:89], v19 offset:1024
    v_mfma_f32_16x16x32_bf16 v[48:51], v[112:115], v[132:135], v[48:51]
    ds_read_b64_tr_b16 v[90:91], v19 offset:1536
    v_mfma_f32_16x16x32_bf16 v[52:55], v[112:115], v[140:143], v[52:55]
    ds_read_b64_tr_b16 v[92:93], v20 offset:1024
    ds_read_b64_tr_b16 v[94:95], v20 offset:1536
    v_mfma_f32_16x16x32_bf16 v[56:59], v[116:119], v[132:135], v[56:59]
    ds_read_b64_tr_b16 v[96:97], v19 offset:2048
    v_mfma_f32_16x16x32_bf16 v[60:63], v[116:119], v[140:143], v[60:63]
    ds_read_b64_tr_b16 v[98:99], v19 offset:2560
    v_mfma_f32_16x16x32_bf16 v[64:67], v[132:135], v[120:123], v[64:67]
    ds_read_b64_tr_b16 v[100:101], v20 offset:2048
    v_mfma_f32_16x16x32_bf16 v[68:71], v[140:143], v[120:123], v[68:71]
    ds_read_b64_tr_b16 v[102:103], v20 offset:2560
    v_mfma_f32_16x16x32_bf16 v[72:75], v[132:135], v[124:127], v[72:75]
    v_mfma_f32_16x16x32_bf16 v[76:79], v[140:143], v[124:127], v[76:79]
    s_cmp_lg_u32 s23, 1
    s_cbranch_scc1 K1_CE11
    s_cbranch_vccnz K1_CB11
    v_smfmac_f32_16x16x64_bf16 v[144:147], v[156:159], v[104:111], v152
    s_branch K1_CC11
K1_CB11:
    v_smfmac_f32_16x16x64_bf16 v[144:147], v[156:159], v[112:119], v152
K1_CC11:
    s_xor_b32 s50, s50, 1
    s_cbranch_scc0 K1_CE11
    v_smfmac_f32_16x16x64_bf16 v[148:151], v[156:159], v[120:127], v152
K1_CE11:
    s_waitcnt lgkmcnt(0)
    v_mfma_f32_16x16x32_bf16 v[32:35], v[80:83], v[128:131], v[32:35]
    ds_read_b128 v[132:135], v9
    ds_read_b128 v[140:143], v10
    v_mfma_f32_16x16x32_bf16 v[36:39], v[80:83], v[136:139], v[36:39]
    ds_read_b64_tr_b16 v[104:105], v19 offset:12288
    v_mfma_f32_16x16x32_bf16 v[40:43], v[84:87], v[128:131], v[40:43]
    ds_read_b64_tr_b16 v[106:107], v19 offset:12800
    v_mfma_f32_16x16x32_bf16 v[44:47], v[84:87], v[136:139], v[44:47]
    ds_read_b64_tr_b16 v[108:109], v20 offset:12288
    v_mfma_f32_16x16x32_bf16 v[160:163], v[128:131], v[128:131], v[160:163]
    ds_read_b64_tr_b16 v[110:111], v20 offset:12800
    ds_read_b64_tr_b16 v[112:113], v19 offset:13312
    v_mfma_f32_16x16x32_bf16 v[48:51], v[88:91], v[128:131], v[48:51]
    ds_read_b64_tr_b16 v[114:115], v19 offset:13824
    v_mfma_f32_16x16x32_bf16 v[52:55], v[88:91], v[136:139], v[52:55]
    ds_read_b64_tr_b16 v[116:117], v20 offset:13312
    v_mfma_f32_16x16x32_bf16 v[56:59], v[92:95], v[128:131], v[56:59]
    ds_read_b64_tr_b16 v[118:119], v20 offset:13824
    v_mfma_f32_16x16x32_bf16 v[60:63], v[92:95], v[136:139], v[60:63]
    ds_read_b64_tr_b16 v[120:121], v19 offset:14336
    ds_read_b64_tr_b16 v[122:123], v19 offset:14848
    v_mfma_f32_16x16x32_bf16 v[64:67], v[128:131], v[96:99], v[64:67]
    ds_read_b64_tr_b16 v[124:125], v20 offset:14336
    v_mfma_f32_16x16x32_bf16 v[68:71], v[136:139], v[96:99], v[68:71]
    ds_read_b64_tr_b16 v[126:127], v20 offset:14848
    v_mfma_f32_16x16x32_bf16 v[72:75], v[128:131], v[100:103], v[72:75]
    v_mfma_f32_16x16x32_bf16 v[76:79], v[136:139], v[100:103], v[76:79]
    s_cmp_lg_u32 s23, 0
    s_cbranch_scc1 K1_CE12
    s_cbranch_vccnz K1_CB12
    v_smfmac_f32_16x16x64_bf16 v[144:147], v[156:159], v[80:87], v152
    s_branch K1_CC12
K1_CB12:
    v_smfmac_f32_16x16x64_bf16 v[144:147], v[156:159], v[88:95], v152
K1_CC12:
    s_xor_b32 s50, s50, 1
    s_cbranch_scc0 K1_CE12
    v_smfmac_f32_16x16x64_bf16 v[148:151], v[156:159], v[96:103], v152
K1_CE12:
    s_waitcnt lgkmcnt(0)
    v_smfmac_f32_16x16x64_bf16 v[164:167], v[156:159], v[128:135], v152
    v_mfma_f32_16x16x32_bf16 v[32:35], v[104:107], v[132:135], v[32:35]
    v_mfma_f32_16x16x32_bf16 v[36:39], v[104:107], v[140:143], v[36:39]
    v_mfma_f32_16x16x32_bf16 v[40:43], v[108:111], v[132:135], v[40:43]
    v_mfma_f32_16x16x32_bf16 v[44:47], v[108:111], v[140:143], v[44:47]
    v_mfma_f32_16x16x32_bf16 v[160:163], v[132:135], v[132:135], v[160:163]
    v_mfma_f32_16x16x32_bf16 v[48:51], v[112:115], v[132:135], v[48:51]
    v_mfma_f32_16x16x32_bf16 v[52:55], v[112:115], v[140:143], v[52:55]
    v_mfma_f32_16x16x32_bf16 v[56:59], v[116:119], v[132:135], v[56:59]
    v_mfma_f32_16x16x32_bf16 v[60:63], v[116:119], v[140:143], v[60:63]
    v_mfma_f32_16x16x32_bf16 v[64:67], v[132:135], v[120:123], v[64:67]
    v_mfma_f32_16x16x32_bf16 v[68:71], v[140:143], v[120:123], v[68:71]
    v_mfma_f32_16x16x32_bf16 v[72:75], v[132:135], v[124:127], v[72:75]
    v_mfma_f32_16x16x32_bf16 v[76:79], v[140:143], v[124:127], v[76:79]
    s_cmp_lg_u32 s23, 1
    s_cbranch_scc1 K1_CE13
    s_cbranch_vccnz K1_CB13
    v_smfmac_f32_16x16x64_bf16 v[144:147], v[156:159], v[104:111], v152
    s_branch K1_CC13
K1_CB13:
    v_smfmac_f32_16x16x64_bf16 v[144:147], v[156:159], v[112:119], v152
K1_CC13:
    s_xor_b32 s50, s50, 1
    s_cbranch_scc0 K1_CE13
    v_smfmac_f32_16x16x64_bf16 v[148:151], v[156:159], v[120:127], v152
K1_CE13:
    s_nop 5
    v_add_f32 v144, v144, v145
    v_add_f32 v146, v146, v147
    v_add_f32 v148, v148, v149
    v_add_f32 v150, v150, v151
    v_pk_add_f32 v[164:165], v[164:165], v[166:167]
    s_mov_b64 exec, 0xffff
    ds_write_b32 v168, v144
    ds_write_b32 v168, v146 offset:128
    ds_write_b32 v175, v148 offset:512
    ds_write_b32 v175, v150 offset:768
    s_mov_b64 exec, -1
    v_add_f32 v164, v164, v165
    s_mov_b32 s40, 0x22222222
    s_mov_b32 s41, 0x22222222
    s_mov_b32 s42, 0x44444444
    s_mov_b32 s43, 0x44444444
    s_mov_b32 s44, 0x88888888
    s_mov_b32 s45, 0x88888888
    v_cndmask_b32 v80, v160, v161, s[40:41]
    v_cndmask_b32 v81, v162, v163, s[44:45]
    v_mul_f32 v82, 0xba800000, v164
    s_or_b64 s[42:43], s[42:43], s[44:45]
    v_cndmask_b32 v80, v80, v81, s[42:43]
    v_mul_f32 v83, v82, v82
    v_mov_b32 v84, 0x3a800000
    v_fma_f32 v80, v80, v84, -v83
    v_max_f32 v80, 0, v80
    v_add_f32 v80, 0x3727c5ac, v80
    v_rsq_f32 v83, v80
    s_mov_b32 exec_lo, 0x00f0000f
    s_mov_b32 exec_hi, 0xf0000f00
    ds_write_b32 v171, v82
    ds_write_b32 v171, v83 offset:512
    s_mov_b64 exec, -1
    s_waitcnt lgkmcnt(0)
    s_barrier
    ds_read_b128 v[80:83], v169 offset:0
    ds_read_b128 v[96:99], v169 offset:64
    ds_read_b128 v[84:87], v169 offset:128
    ds_read_b128 v[100:103], v169 offset:192
    ds_read_b128 v[88:91], v169 offset:256
    ds_read_b128 v[104:107], v169 offset:320
    ds_read_b128 v[92:95], v169 offset:384
    ds_read_b128 v[108:111], v169 offset:448
    ds_read_b32 v136, v171
    ds_read_b32 v137, v171 offset:512
    ds_read_b32 v138, v173
    ds_read_b32 v139, v173 offset:512
    ds_read_b32 v112, v170 offset:512
    ds_read_b32 v114, v170 offset:576
    ds_read_b32 v140, v170 offset:640
    ds_read_b32 v142, v170 offset:704
    ds_read_b32 v113, v170 offset:768
    ds_read_b32 v115, v170 offset:832
    ds_read_b32 v141, v170 offset:896
    ds_read_b32 v143, v170 offset:960
    ds_read_b128 v[120:123], v172
    ds_read_b128 v[124:127], v172 offset:512
    ds_read_b128 v[128:131], v174
    ds_read_b128 v[132:135], v174 offset:512
    s_waitcnt lgkmcnt(12)
    v_pk_add_f32 v[80:81], v[80:81], v[96:97]
    v_pk_add_f32 v[82:83], v[82:83], v[98:99]
    v_pk_add_f32 v[84:85], v[84:85], v[100:101]
    v_pk_add_f32 v[86:87], v[86:87], v[102:103]
    v_pk_add_f32 v[88:89], v[88:89], v[104:105]
    v_pk_add_f32 v[90:91], v[90:91], v[106:107]
    v_pk_add_f32 v[92:93], v[92:93], v[108:109]
    v_pk_add_f32 v[94:95], v[94:95], v[110:111]
    v_mov_b32 v116, v136
    v_mul_f32 v117, 0x3e8293ee, v137
    v_mov_b32 v118, v138
    v_mul_f32 v119, 0x3e8293ee, v139
    v_pk_fma_f32 v[32:33], v[80:81], v[116:117], v[32:33] op_sel_hi:[1,0,1]
    v_pk_fma_f32 v[34:35], v[82:83], v[116:117], v[34:35] op_sel_hi:[1,0,1]
    v_pk_fma_f32 v[40:41], v[84:85], v[116:117], v[40:41] op_sel_hi:[1,0,1]
    v_pk_fma_f32 v[42:43], v[86:87], v[116:117], v[42:43] op_sel_hi:[1,0,1]
    v_pk_mul_f32 v[32:33], v[32:33], v[116:117] op_sel:[0,1] op_sel_hi:[1,1]
    v_pk_mul_f32 v[34:35], v[34:35], v[116:117] op_sel:[0,1] op_sel_hi:[1,1]
    v_pk_mul_f32 v[40:41], v[40:41], v[116:117] op_sel:[0,1] op_sel_hi:[1,1]
    v_pk_mul_f32 v[42:43], v[42:43], v[116:117] op_sel:[0,1] op_sel_hi:[1,1]
    v_cvt_pk_bf16_f32 v96, v32, v33
    v_cvt_pk_bf16_f32 v97, v34, v35
    v_cvt_pk_bf16_f32 v98, v40, v41
    v_cvt_pk_bf16_f32 v99, v42, v43
    buffer_store_dwordx4 v[96:99], v1, s[8:11], s37 offen sc1
    v_pk_fma_f32 v[36:37], v[80:81], v[118:119], v[36:37] op_sel_hi:[1,0,1]
    v_pk_fma_f32 v[38:39], v[82:83], v[118:119], v[38:39] op_sel_hi:[1,0,1]
    v_pk_fma_f32 v[44:45], v[84:85], v[118:119], v[44:45] op_sel_hi:[1,0,1]
    v_pk_fma_f32 v[46:47], v[86:87], v[118:119], v[46:47] op_sel_hi:[1,0,1]
    v_pk_mul_f32 v[36:37], v[36:37], v[118:119] op_sel:[0,1] op_sel_hi:[1,1]
    v_pk_mul_f32 v[38:39], v[38:39], v[118:119] op_sel:[0,1] op_sel_hi:[1,1]
    v_pk_mul_f32 v[44:45], v[44:45], v[118:119] op_sel:[0,1] op_sel_hi:[1,1]
    v_pk_mul_f32 v[46:47], v[46:47], v[118:119] op_sel:[0,1] op_sel_hi:[1,1]
    v_cvt_pk_bf16_f32 v100, v36, v37
    v_cvt_pk_bf16_f32 v101, v38, v39
    v_cvt_pk_bf16_f32 v102, v44, v45
    v_cvt_pk_bf16_f32 v103, v46, v47
    buffer_store_dwordx4 v[100:103], v1, s[8:11], s38 offen sc1
    v_pk_fma_f32 v[48:49], v[88:89], v[136:137], v[48:49] op_sel_hi:[1,0,1]
    v_pk_fma_f32 v[50:51], v[90:91], v[136:137], v[50:51] op_sel_hi:[1,0,1]
    v_pk_fma_f32 v[56:57], v[92:93], v[136:137], v[56:57] op_sel_hi:[1,0,1]
    v_pk_fma_f32 v[58:59], v[94:95], v[136:137], v[58:59] op_sel_hi:[1,0,1]
    v_pk_mul_f32 v[48:49], v[48:49], v[136:137] op_sel:[0,1] op_sel_hi:[1,1]
    v_pk_mul_f32 v[50:51], v[50:51], v[136:137] op_sel:[0,1] op_sel_hi:[1,1]
    v_pk_mul_f32 v[56:57], v[56:57], v[136:137] op_sel:[0,1] op_sel_hi:[1,1]
    v_pk_mul_f32 v[58:59], v[58:59], v[136:137] op_sel:[0,1] op_sel_hi:[1,1]
    v_cvt_pk_bf16_f32 v104, v48, v49
    v_cvt_pk_bf16_f32 v105, v50, v51
    v_cvt_pk_bf16_f32 v106, v56, v57
    v_cvt_pk_bf16_f32 v107, v58, v59
    buffer_store_dwordx4 v[104:107], v1, s[8:11], s39 offen sc1
    v_pk_fma_f32 v[52:53], v[88:89], v[138:139], v[52:53] op_sel_hi:[1,0,1]
    v_pk_fma_f32 v[54:55], v[90:91], v[138:139], v[54:55] op_sel_hi:[1,0,1]
    v_pk_fma_f32 v[60:61], v[92:93], v[138:139], v[60:61] op_sel_hi:[1,0,1]
    v_pk_fma_f32 v[62:63], v[94:95], v[138:139], v[62:63] op_sel_hi:[1,0,1]
    v_pk_mul_f32 v[52:53], v[52:53], v[138:139] op_sel:[0,1] op_sel_hi:[1,1]
    v_pk_mul_f32 v[54:55], v[54:55], v[138:139] op_sel:[0,1] op_sel_hi:[1,1]
    v_pk_mul_f32 v[60:61], v[60:61], v[138:139] op_sel:[0,1] op_sel_hi:[1,1]
    v_pk_mul_f32 v[62:63], v[62:63], v[138:139] op_sel:[0,1] op_sel_hi:[1,1]
    v_cvt_pk_bf16_f32 v108, v52, v53
    v_cvt_pk_bf16_f32 v109, v54, v55
    v_cvt_pk_bf16_f32 v110, v60, v61
    v_cvt_pk_bf16_f32 v111, v62, v63
    buffer_store_dwordx4 v[108:111], v1, s[8:11], s48 offen sc1
    s_waitcnt lgkmcnt(0)
    v_pk_add_f32 v[112:113], v[112:113], v[114:115]
    v_pk_add_f32 v[140:141], v[140:141], v[142:143]
    v_pk_add_f32 v[112:113], v[112:113], v[140:141]
    v_pk_fma_f32 v[64:65], v[120:121], v[112:113], v[64:65] op_sel:[0,0,0] op_sel_hi:[1,0,1]
    v_pk_fma_f32 v[66:67], v[122:123], v[112:113], v[66:67] op_sel:[0,0,0] op_sel_hi:[1,0,1]
    v_pk_fma_f32 v[68:69], v[128:129], v[112:113], v[68:69] op_sel:[0,0,0] op_sel_hi:[1,0,1]
    v_pk_fma_f32 v[70:71], v[130:131], v[112:113], v[70:71] op_sel:[0,0,0] op_sel_hi:[1,0,1]
    v_pk_mul_f32 v[64:65], v[64:65], v[124:125]
    v_pk_mul_f32 v[66:67], v[66:67], v[126:127]
    v_pk_mul_f32 v[68:69], v[68:69], v[132:133]
    v_pk_mul_f32 v[70:71], v[70:71], v[134:135]
    v_pk_fma_f32 v[72:73], v[120:121], v[112:113], v[72:73] op_sel:[0,1,0] op_sel_hi:[1,1,1]
    v_pk_fma_f32 v[74:75], v[122:123], v[112:113], v[74:75] op_sel:[0,1,0] op_sel_hi:[1,1,1]
    v_pk_fma_f32 v[76:77], v[128:129], v[112:113], v[76:77] op_sel:[0,1,0] op_sel_hi:[1,1,1]
    v_pk_fma_f32 v[78:79], v[130:131], v[112:113], v[78:79] op_sel:[0,1,0] op_sel_hi:[1,1,1]
    v_pk_mul_f32 v[72:73], v[72:73], v[124:125]
    v_pk_mul_f32 v[74:75], v[74:75], v[126:127]
    v_pk_mul_f32 v[76:77], v[76:77], v[132:133]
    v_pk_mul_f32 v[78:79], v[78:79], v[134:135]
    s_cmp_eq_u32 s22, 0
    s_cbranch_scc0 K1_VSW
    v_cvt_pk_bf16_f32 v80, v64, v65
    v_cvt_pk_bf16_f32 v81, v66, v67
    v_cvt_pk_bf16_f32 v82, v68, v69
    v_cvt_pk_bf16_f32 v83, v70, v71
    v_cvt_pk_bf16_f32 v84, v72, v73
    v_cvt_pk_bf16_f32 v85, v74, v75
    v_cvt_pk_bf16_f32 v86, v76, v77
    v_cvt_pk_bf16_f32 v87, v78, v79
    s_branch K1_VST
K1_VSW:
    v_cvt_pk_bf16_f32 v82, v64, v65
    v_cvt_pk_bf16_f32 v83, v66, v67
    v_cvt_pk_bf16_f32 v80, v68, v69
    v_cvt_pk_bf16_f32 v81, v70, v71
    v_cvt_pk_bf16_f32 v86, v72, v73
    v_cvt_pk_bf16_f32 v87, v74, v75
    v_cvt_pk_bf16_f32 v84, v76, v77
    v_cvt_pk_bf16_f32 v85, v78, v79
K1_VST:
    buffer_store_dwordx4 v[80:83], v1, s[8:11], s34 offen offset:2048 sc1
    buffer_store_dwordx4 v[84:87], v1, s[8:11], s34 offen offset:3072 sc1
K1_END:
    s_endpgm
.globl attn_kernel
.p2align 8
.type attn_kernel,@function
attn_kernel:
    s_cmp_ge_u32 s2, 256
    s_cbranch_scc1 K2_END
    s_load_dwordx2 s[36:37], s[0:1], 72
    v_lshrrev_b32 v1, 6, v0
    v_and_b32 v0, 63, v0
    v_readfirstlane_b32 s3, v1
    s_nop 0
    s_cmp_lg_u32 s3, 0
    s_cbranch_scc1 CPF5_X
    v_min_u32 v2, 3, v0
    s_lshr_b32 s62, s2, 3
    s_mul_i32 s62, s62, 512
    v_lshl_add_u32 v2, v2, 7, s62
    v_min_u32 v2, TEXT_END-CPF5-4, v2
    s_getpc_b64 s[62:63]
CPF5:
    v_mov_b32 v3, s63
    v_add_co_u32 v2, vcc, s62, v2
    s_nop 1
    v_addc_co_u32 v3, vcc, 0, v3, vcc
    global_load_dword v115, v[2:3], off
CPF5_X:
    s_cmp_ge_u32 s3, 8
    s_cbranch_scc1 K2_PACK
    s_and_b32 s16, s2, 7
    s_lshr_b32 s17, s2, 3
    s_lshl_b32 s18, s16, 2
    s_and_b32 s19, s17, 3
    s_add_u32 s18, s18, s19
    s_lshr_b32 s19, s17, 2
    s_lshl_b32 s20, s18, 7
    s_lshl_b32 s21, s19, 4
    s_add_u32 s20, s20, s21
    s_lshl_b32 s21, s3, 1
    s_add_u32 s20, s20, s21
    s_lshl_b32 s20, s20, 10
    s_add_u32 s21, s20, 4194304
    s_add_u32 s22, s20, 16777216
    s_lshl_b32 s23, s18, 18
    s_add_u32 s23, s23, 8388608
    s_lshl_b32 s24, s3, 11
    s_add_u32 s27, s23, s24
    s_mov_b32 s28, 0
    s_mov_b32 s40, 0x07060302
    v_lshlrev_b32 v1, 4, v0
    v_bfe_u32 v4, v0, 4, 1
    v_lshlrev_b32 v4, 10, v4
    v_lshrrev_b32 v5, 5, v0
    v_lshl_add_u32 v4, v5, 8, v4
    v_and_b32 v6, 15, v0
    v_lshl_add_u32 v2, v6, 4, v4
    v_bfe_u32 v4, v0, 2, 1
    v_lshlrev_b32 v4, 10, v4
    v_lshl_add_u32 v4, v5, 8, v4
    v_bfe_u32 v6, v0, 3, 2
    v_lshl_add_u32 v4, v6, 6, v4
    v_and_b32 v6, 3, v0
    v_lshl_add_u32 v3, v6, 4, v4
    s_waitcnt lgkmcnt(0)
    s_mov_b32 s8, s36
    s_mov_b32 s9, s37
    s_mov_b32 s10, 0x10000000
    s_mov_b32 s11, 0x00020000
    s_mov_b32 s25, 0
    s_mov_b32 s33, 0
    s_add_u32 s26, s27, s25
    s_add_u32 m0, s24, s33
    s_nop 0
    buffer_load_dwordx4 v1, s[8:11], s26 offen lds
    buffer_load_dwordx4 v1, s[8:11], s26 offen offset:1024 lds
    s_add_u32 s25, s25, 16384
    s_add_u32 s33, s33, 16384
    s_cmp_eq_u32 s33, 81920
    s_cselect_b32 s33, 0, s33
    buffer_load_dwordx4 v[8:11], v2, s[8:11], s21 offen offset:0
    buffer_load_dwordx4 v[12:15], v2, s[8:11], s21 offen offset:512
    v_and_b32 v4, 7, v0
    v_mov_b32 v5, 0x3f803f80
    v_cmp_eq_u32 vcc, 0, v4
    s_nop 1
    v_cndmask_b32 v40, 0, v5, vcc
    v_cndmask_b32 v41, 0, v5, vcc
    v_cmp_eq_u32 vcc, 4, v4
    s_nop 1
    v_cndmask_b32 v42, 0, v5, vcc
    v_cndmask_b32 v43, 0, v5, vcc
    v_mov_b32 v148, 0xdddddddd
    v_mov_b32 v64, 0
    v_mov_b32 v65, 0
    v_mov_b32 v66, 0
    v_mov_b32 v67, 0
    v_mov_b32 v68, 0
    v_mov_b32 v69, 0
    v_mov_b32 v70, 0
    v_mov_b32 v71, 0
    v_mov_b32 v72, 0
    v_mov_b32 v73, 0
    v_mov_b32 v74, 0
    v_mov_b32 v75, 0
    v_mov_b32 v76, 0
    v_mov_b32 v77, 0
    v_mov_b32 v78, 0
    v_mov_b32 v79, 0
    v_mov_b32 v6, 81920
    v_mov_b32 v7, 0
    ds_write_b32 v6, v7
    s_branch K2_RUN1
K2_RUN:
    s_mov_b32 s25, 0
    s_mov_b32 s33, 0
    s_add_u32 s26, s27, s25
    s_add_u32 m0, s24, s33
    s_nop 0
    buffer_load_dwordx4 v1, s[8:11], s26 offen lds
    buffer_load_dwordx4 v1, s[8:11], s26 offen offset:1024 lds
    s_add_u32 s25, s25, 16384
    s_add_u32 s33, s33, 16384
    s_cmp_eq_u32 s33, 81920
    s_cselect_b32 s33, 0, s33
K2_RUN1:
    s_add_u32 s26, s27, s25
    s_add_u32 m0, s24, s33
    s_nop 0
    buffer_load_dwordx4 v1, s[8:11], s26 offen lds
    buffer_load_dwordx4 v1, s[8:11], s26 offen offset:1024 lds
    s_add_u32 s25, s25, 16384
    s_add_u32 s33, s33, 16384
    s_cmp_eq_u32 s33, 81920
    s_cselect_b32 s33, 0, s33
    s_add_u32 s26, s27, s25
    s_add_u32 m0, s24, s33
    s_nop 0
    buffer_load_dwordx4 v1, s[8:11], s26 offen lds
    buffer_load_dwordx4 v1, s[8:11], s26 offen offset:1024 lds
    s_add_u32 s25, s25, 16384
    s_add_u32 s33, s33, 16384
    s_cmp_eq_u32 s33, 81920
    s_cselect_b32 s33, 0, s33
    s_add_u32 s26, s27, s25
    s_add_u32 m0, s24, s33
    s_nop 0
    buffer_load_dwordx4 v1, s[8:11], s26 offen lds
    buffer_load_dwordx4 v1, s[8:11], s26 offen offset:1024 lds
    s_add_u32 s25, s25, 16384
    s_add_u32 s33, s33, 16384
    s_cmp_eq_u32 s33, 81920
    s_cselect_b32 s33, 0, s33
    s_mov_b32 s34, 16384
    v_mov_b32 v144, v3
    v_mov_b32 v146, v2
    v_mov_b64 v[48:49], 0
    v_mov_b64 v[50:51], 0
    v_mov_b64 v[52:53], 0
    v_mov_b64 v[54:55], 0
    v_mov_b64 v[56:57], 0
    v_mov_b64 v[58:59], 0
    v_mov_b64 v[60:61], 0
    v_mov_b64 v[62:63], 0
    v_mov_b32 v44, 0
    v_mov_b32 v28, 0
    v_mov_b32 v128, 0
    v_mov_b32 v132, 0
    v_mov_b32 v136, 0
    v_mov_b32 v140, 0
    v_mov_b32 v45, 0
    v_mov_b32 v29, 0
    v_mov_b32 v129, 0
    v_mov_b32 v133, 0
    v_mov_b32 v137, 0
    v_mov_b32 v141, 0
    v_mov_b32 v46, 0
    v_mov_b32 v30, 0
    v_mov_b32 v130, 0
    v_mov_b32 v134, 0
    v_mov_b32 v138, 0
    v_mov_b32 v142, 0
    v_mov_b32 v47, 0
    v_mov_b32 v31, 0
    v_mov_b32 v131, 0
    v_mov_b32 v135, 0
    v_mov_b32 v139, 0
    v_mov_b32 v143, 0
    s_waitcnt vmcnt(6) lgkmcnt(0)
    s_barrier
    ds_read_b128 v[16:19], v144 offset:0
    ds_read_b128 v[20:23], v144 offset:512
    s_waitcnt lgkmcnt(0)
    v_mfma_f32_32x32x16_bf16 v[80:95], v[16:19], v[8:11], v[64:79]
    v_mfma_f32_32x32x16_bf16 v[80:95], v[20:23], v[12:15], v[80:95]
    ds_read_b128 v[16:19], v144 offset:4096
    ds_read_b128 v[20:23], v144 offset:4608
    ds_read_b128 v[24:27], v146 offset:2048
    s_waitcnt lgkmcnt(0)
    s_mov_b32 s30, 4
K2_LOOP:
    s_waitcnt lgkmcnt(3)
    v_mfma_f32_32x32x16_bf16 v[96:111], v[16:19], v[8:11], v[64:79]
    s_nop 4
    v_exp_f32 v80, v80
    v_exp_f32 v81, v81
    ds_read_b128 v[16:19], v144 offset:8192
    v_exp_f32 v82, v82
    v_smfmac_f32_16x16x64_bf16 v[44:47], v[40:43], v[128:135], v148
    v_exp_f32 v83, v83
    s_waitcnt lgkmcnt(3)
    v_smfmac_f32_32x32x32_bf16 v[48:63], v[28:31], v[136:143], v148
    v_exp_f32 v84, v84
    v_exp_f32 v85, v85
    ds_read_b128 v[28:31], v146 offset:2560
    v_exp_f32 v86, v86
    s_waitcnt lgkmcnt(3)
    v_mfma_f32_32x32x16_bf16 v[96:111], v[20:23], v[12:15], v[96:111]
    v_exp_f32 v87, v87
    v_exp_f32 v88, v88
    ds_read_b128 v[20:23], v144 offset:8704
    v_exp_f32 v89, v89
    v_smfmac_f32_16x16x64_bf16 v[44:47], v[40:43], v[136:143], v148
    v_exp_f32 v90, v90
    s_waitcnt lgkmcnt(3)
    v_smfmac_f32_32x32x32_bf16 v[48:63], v[24:27], v[80:87], v148
    v_exp_f32 v91, v91
    v_exp_f32 v92, v92
    ds_read_b128 v[24:27], v146 offset:6144
    v_exp_f32 v93, v93
    v_exp_f32 v94, v94
    v_exp_f32 v95, v95
    s_waitcnt lgkmcnt(3)
    v_mfma_f32_32x32x16_bf16 v[112:127], v[16:19], v[8:11], v[64:79]
    v_exp_f32 v96, v96
    v_exp_f32 v97, v97
    ds_read_b128 v[16:19], v144 offset:12288
    v_exp_f32 v98, v98
    v_smfmac_f32_16x16x64_bf16 v[44:47], v[40:43], v[80:87], v148
    v_exp_f32 v99, v99
    s_waitcnt lgkmcnt(3)
    v_smfmac_f32_32x32x32_bf16 v[48:63], v[28:31], v[88:95], v148
    v_exp_f32 v100, v100
    v_exp_f32 v101, v101
    ds_read_b128 v[28:31], v146 offset:6656
    v_exp_f32 v102, v102
    s_waitcnt lgkmcnt(3)
    v_mfma_f32_32x32x16_bf16 v[112:127], v[20:23], v[12:15], v[112:127]
    v_exp_f32 v103, v103
    v_exp_f32 v104, v104
    ds_read_b128 v[20:23], v144 offset:12800
    v_exp_f32 v105, v105
    v_smfmac_f32_16x16x64_bf16 v[44:47], v[40:43], v[88:95], v148
    v_exp_f32 v106, v106
    s_waitcnt lgkmcnt(3)
    v_smfmac_f32_32x32x32_bf16 v[48:63], v[24:27], v[96:103], v148
    v_exp_f32 v107, v107
    v_exp_f32 v108, v108
    ds_read_b128 v[24:27], v146 offset:10240
    v_exp_f32 v109, v109
    v_exp_f32 v110, v110
    v_exp_f32 v111, v111
    s_waitcnt lgkmcnt(3)
    v_mfma_f32_32x32x16_bf16 v[128:143], v[16:19], v[8:11], v[64:79]
    v_exp_f32 v112, v112
    v_exp_f32 v113, v113
    v_add_u32 v145, s34, v3
    v_add_u32 v147, s34, v2
    s_add_u32 s34, s34, 16384
    s_cmp_eq_u32 s34, 81920
    s_cselect_b32 s34, 0, s34
    s_waitcnt vmcnt(4)
    s_cmp_eq_u32 s30, 1
    s_barrier
    s_cbranch_scc1 K2_D0
    s_add_u32 s26, s27, s25
    s_add_u32 m0, s24, s33
    s_nop 0
    buffer_load_dwordx4 v1, s[8:11], s26 offen lds
    buffer_load_dwordx4 v1, s[8:11], s26 offen offset:1024 lds
    s_add_u32 s25, s25, 16384
    s_add_u32 s33, s33, 16384
    s_cmp_eq_u32 s33, 81920
    s_cselect_b32 s33, 0, s33
K2_D0:
    ds_read_b128 v[16:19], v145 offset:0
    v_exp_f32 v114, v114
    v_smfmac_f32_16x16x64_bf16 v[44:47], v[40:43], v[96:103], v148
    v_exp_f32 v115, v115
    s_waitcnt lgkmcnt(3)
    v_smfmac_f32_32x32x32_bf16 v[48:63], v[28:31], v[104:111], v148
    v_exp_f32 v116, v116
    v_exp_f32 v117, v117
    ds_read_b128 v[28:31], v146 offset:10752
    v_exp_f32 v118, v118
    s_waitcnt lgkmcnt(3)
    v_mfma_f32_32x32x16_bf16 v[128:143], v[20:23], v[12:15], v[128:143]
    v_exp_f32 v119, v119
    v_exp_f32 v120, v120
    ds_read_b128 v[20:23], v145 offset:512
    v_exp_f32 v121, v121
    v_smfmac_f32_16x16x64_bf16 v[44:47], v[40:43], v[104:111], v148
    v_exp_f32 v122, v122
    s_waitcnt lgkmcnt(3)
    v_smfmac_f32_32x32x32_bf16 v[48:63], v[24:27], v[112:119], v148
    v_exp_f32 v123, v123
    v_exp_f32 v124, v124
    ds_read_b128 v[24:27], v146 offset:14336
    v_exp_f32 v125, v125
    v_exp_f32 v126, v126
    v_exp_f32 v127, v127
    s_waitcnt lgkmcnt(3)
    v_mfma_f32_32x32x16_bf16 v[80:95], v[16:19], v[8:11], v[64:79]
    v_exp_f32 v128, v128
    v_exp_f32 v129, v129
    ds_read_b128 v[16:19], v145 offset:4096
    v_exp_f32 v130, v130
    v_smfmac_f32_16x16x64_bf16 v[44:47], v[40:43], v[112:119], v148
    v_exp_f32 v131, v131
    s_waitcnt lgkmcnt(3)
    v_smfmac_f32_32x32x32_bf16 v[48:63], v[28:31], v[120:127], v148
    v_exp_f32 v132, v132
    v_exp_f32 v133, v133
    ds_read_b128 v[28:31], v146 offset:14848
    v_exp_f32 v134, v134
    s_waitcnt lgkmcnt(3)
    v_mfma_f32_32x32x16_bf16 v[80:95], v[20:23], v[12:15], v[80:95]
    v_exp_f32 v135, v135
    v_exp_f32 v136, v136
    ds_read_b128 v[20:23], v145 offset:4608
    v_exp_f32 v137, v137
    v_smfmac_f32_16x16x64_bf16 v[44:47], v[40:43], v[120:127], v148
    v_exp_f32 v138, v138
    s_waitcnt lgkmcnt(3)
    v_smfmac_f32_32x32x32_bf16 v[48:63], v[24:27], v[128:135], v148
    v_exp_f32 v139, v139
    v_exp_f32 v140, v140
    ds_read_b128 v[24:27], v147 offset:2048
    v_exp_f32 v141, v141
    v_exp_f32 v142, v142
    v_exp_f32 v143, v143
    s_waitcnt lgkmcnt(3)
    v_mfma_f32_32x32x16_bf16 v[96:111], v[16:19], v[8:11], v[64:79]
    v_exp_f32 v80, v80
    v_exp_f32 v81, v81
    ds_read_b128 v[16:19], v145 offset:8192
    v_exp_f32 v82, v82
    v_smfmac_f32_16x16x64_bf16 v[44:47], v[40:43], v[128:135], v148
    v_exp_f32 v83, v83
    s_waitcnt lgkmcnt(3)
    v_smfmac_f32_32x32x32_bf16 v[48:63], v[28:31], v[136:143], v148
    v_exp_f32 v84, v84
    v_exp_f32 v85, v85
    ds_read_b128 v[28:31], v147 offset:2560
    v_exp_f32 v86, v86
    s_waitcnt lgkmcnt(3)
    v_mfma_f32_32x32x16_bf16 v[96:111], v[20:23], v[12:15], v[96:111]
    v_exp_f32 v87, v87
    v_exp_f32 v88, v88
    ds_read_b128 v[20:23], v145 offset:8704
    v_exp_f32 v89, v89
    v_smfmac_f32_16x16x64_bf16 v[44:47], v[40:43], v[136:143], v148
    v_exp_f32 v90, v90
    s_waitcnt lgkmcnt(3)
    v_smfmac_f32_32x32x32_bf16 v[48:63], v[24:27], v[80:87], v148
    v_exp_f32 v91, v91
    v_exp_f32 v92, v92
    ds_read_b128 v[24:27], v147 offset:6144
    v_exp_f32 v93, v93
    v_exp_f32 v94, v94
    v_exp_f32 v95, v95
    s_waitcnt lgkmcnt(3)
    v_mfma_f32_32x32x16_bf16 v[112:127], v[16:19], v[8:11], v[64:79]
    v_exp_f32 v96, v96
    v_exp_f32 v97, v97
    ds_read_b128 v[16:19], v145 offset:12288
    v_exp_f32 v98, v98
    v_smfmac_f32_16x16x64_bf16 v[44:47], v[40:43], v[80:87], v148
    v_exp_f32 v99, v99
    s_waitcnt lgkmcnt(3)
    v_smfmac_f32_32x32x32_bf16 v[48:63], v[28:31], v[88:95], v148
    v_exp_f32 v100, v100
    v_exp_f32 v101, v101
    ds_read_b128 v[28:31], v147 offset:6656
    v_exp_f32 v102, v102
    s_waitcnt lgkmcnt(3)
    v_mfma_f32_32x32x16_bf16 v[112:127], v[20:23], v[12:15], v[112:127]
    v_exp_f32 v103, v103
    v_exp_f32 v104, v104
    ds_read_b128 v[20:23], v145 offset:12800
    v_exp_f32 v105, v105
    v_smfmac_f32_16x16x64_bf16 v[44:47], v[40:43], v[88:95], v148
    v_exp_f32 v106, v106
    s_waitcnt lgkmcnt(3)
    v_smfmac_f32_32x32x32_bf16 v[48:63], v[24:27], v[96:103], v148
    v_exp_f32 v107, v107
    v_exp_f32 v108, v108
    ds_read_b128 v[24:27], v147 offset:10240
    v_exp_f32 v109, v109
    v_exp_f32 v110, v110
    v_exp_f32 v111, v111
    s_waitcnt lgkmcnt(3)
    v_mfma_f32_32x32x16_bf16 v[128:143], v[16:19], v[8:11], v[64:79]
    v_exp_f32 v112, v112
    v_exp_f32 v113, v113
    v_add_u32 v144, s34, v3
    v_add_u32 v146, s34, v2
    s_add_u32 s34, s34, 16384
    s_cmp_eq_u32 s34, 81920
    s_cselect_b32 s34, 0, s34
    s_waitcnt vmcnt(4)
    s_cmp_eq_u32 s30, 1
    s_cbranch_scc0 K2_W1
    s_waitcnt vmcnt(2)
K2_W1:
    s_barrier
    s_cbranch_scc1 K2_D1
    s_add_u32 s26, s27, s25
    s_add_u32 m0, s24, s33
    s_nop 0
    buffer_load_dwordx4 v1, s[8:11], s26 offen lds
    buffer_load_dwordx4 v1, s[8:11], s26 offen offset:1024 lds
    s_add_u32 s25, s25, 16384
    s_add_u32 s33, s33, 16384
    s_cmp_eq_u32 s33, 81920
    s_cselect_b32 s33, 0, s33
K2_D1:
    ds_read_b128 v[16:19], v144 offset:0
    v_exp_f32 v114, v114
    v_smfmac_f32_16x16x64_bf16 v[44:47], v[40:43], v[96:103], v148
    v_exp_f32 v115, v115
    s_waitcnt lgkmcnt(3)
    v_smfmac_f32_32x32x32_bf16 v[48:63], v[28:31], v[104:111], v148
    v_exp_f32 v116, v116
    v_exp_f32 v117, v117
    ds_read_b128 v[28:31], v147 offset:10752
    v_exp_f32 v118, v118
    s_waitcnt lgkmcnt(3)
    v_mfma_f32_32x32x16_bf16 v[128:143], v[20:23], v[12:15], v[128:143]
    v_exp_f32 v119, v119
    v_exp_f32 v120, v120
    ds_read_b128 v[20:23], v144 offset:512
    v_exp_f32 v121, v121
    v_smfmac_f32_16x16x64_bf16 v[44:47], v[40:43], v[104:111], v148
    v_exp_f32 v122, v122
    s_waitcnt lgkmcnt(3)
    v_smfmac_f32_32x32x32_bf16 v[48:63], v[24:27], v[112:119], v148
    v_exp_f32 v123, v123
    v_exp_f32 v124, v124
    ds_read_b128 v[24:27], v147 offset:14336
    v_exp_f32 v125, v125
    v_exp_f32 v126, v126
    v_exp_f32 v127, v127
    s_waitcnt lgkmcnt(3)
    v_mfma_f32_32x32x16_bf16 v[80:95], v[16:19], v[8:11], v[64:79]
    v_exp_f32 v128, v128
    v_exp_f32 v129, v129
    ds_read_b128 v[16:19], v144 offset:4096
    v_exp_f32 v130, v130
    v_smfmac_f32_16x16x64_bf16 v[44:47], v[40:43], v[112:119], v148
    v_exp_f32 v131, v131
    s_waitcnt lgkmcnt(3)
    v_smfmac_f32_32x32x32_bf16 v[48:63], v[28:31], v[120:127], v148
    v_exp_f32 v132, v132
    v_exp_f32 v133, v133
    ds_read_b128 v[28:31], v147 offset:14848
    v_exp_f32 v134, v134
    s_waitcnt lgkmcnt(3)
    v_mfma_f32_32x32x16_bf16 v[80:95], v[20:23], v[12:15], v[80:95]
    v_exp_f32 v135, v135
    v_exp_f32 v136, v136
    ds_read_b128 v[20:23], v144 offset:4608
    v_exp_f32 v137, v137
    v_smfmac_f32_16x16x64_bf16 v[44:47], v[40:43], v[120:127], v148
    v_exp_f32 v138, v138
    s_waitcnt lgkmcnt(3)
    v_smfmac_f32_32x32x32_bf16 v[48:63], v[24:27], v[128:135], v148
    v_exp_f32 v139, v139
    v_exp_f32 v140, v140
    ds_read_b128 v[24:27], v146 offset:2048
    v_exp_f32 v141, v141
    v_exp_f32 v142, v142
    v_exp_f32 v143, v143
    s_waitcnt lgkmcnt(3)
    v_mfma_f32_32x32x16_bf16 v[96:111], v[16:19], v[8:11], v[64:79]
    v_exp_f32 v80, v80
    v_exp_f32 v81, v81
    ds_read_b128 v[16:19], v144 offset:8192
    v_exp_f32 v82, v82
    v_smfmac_f32_16x16x64_bf16 v[44:47], v[40:43], v[128:135], v148
    v_exp_f32 v83, v83
    s_waitcnt lgkmcnt(3)
    v_smfmac_f32_32x32x32_bf16 v[48:63], v[28:31], v[136:143], v148
    v_exp_f32 v84, v84
    v_exp_f32 v85, v85
    ds_read_b128 v[28:31], v146 offset:2560
    v_exp_f32 v86, v86
    s_waitcnt lgkmcnt(3)
    v_mfma_f32_32x32x16_bf16 v[96:111], v[20:23], v[12:15], v[96:111]
    v_exp_f32 v87, v87
    v_exp_f32 v88, v88
    ds_read_b128 v[20:23], v144 offset:8704
    v_exp_f32 v89, v89
    v_smfmac_f32_16x16x64_bf16 v[44:47], v[40:43], v[136:143], v148
    v_exp_f32 v90, v90
    s_waitcnt lgkmcnt(3)
    v_smfmac_f32_32x32x32_bf16 v[48:63], v[24:27], v[80:87], v148
    v_exp_f32 v91, v91
    v_exp_f32 v92, v92
    ds_read_b128 v[24:27], v146 offset:6144
    v_exp_f32 v93, v93
    v_exp_f32 v94, v94
    v_exp_f32 v95, v95
    s_waitcnt lgkmcnt(3)
    v_mfma_f32_32x32x16_bf16 v[112:127], v[16:19], v[8:11], v[64:79]
    v_exp_f32 v96, v96
    v_exp_f32 v97, v97
    ds_read_b128 v[16:19], v144 offset:12288
    v_exp_f32 v98, v98
    v_smfmac_f32_16x16x64_bf16 v[44:47], v[40:43], v[80:87], v148
    v_exp_f32 v99, v99
    s_waitcnt lgkmcnt(3)
    v_smfmac_f32_32x32x32_bf16 v[48:63], v[28:31], v[88:95], v148
    v_exp_f32 v100, v100
    v_exp_f32 v101, v101
    ds_read_b128 v[28:31], v146 offset:6656
    v_exp_f32 v102, v102
    s_waitcnt lgkmcnt(3)
    v_mfma_f32_32x32x16_bf16 v[112:127], v[20:23], v[12:15], v[112:127]
    v_exp_f32 v103, v103
    v_exp_f32 v104, v104
    ds_read_b128 v[20:23], v144 offset:12800
    v_exp_f32 v105, v105
    v_smfmac_f32_16x16x64_bf16 v[44:47], v[40:43], v[88:95], v148
    v_exp_f32 v106, v106
    s_waitcnt lgkmcnt(3)
    v_smfmac_f32_32x32x32_bf16 v[48:63], v[24:27], v[96:103], v148
    v_exp_f32 v107, v107
    v_exp_f32 v108, v108
    ds_read_b128 v[24:27], v146 offset:10240
    v_exp_f32 v109, v109
    v_exp_f32 v110, v110
    v_exp_f32 v111, v111
    s_waitcnt lgkmcnt(3)
    v_mfma_f32_32x32x16_bf16 v[128:143], v[16:19], v[8:11], v[64:79]
    v_exp_f32 v112, v112
    v_exp_f32 v113, v113
    v_add_u32 v145, s34, v3
    v_add_u32 v147, s34, v2
    s_add_u32 s34, s34, 16384
    s_cmp_eq_u32 s34, 81920
    s_cselect_b32 s34, 0, s34
    s_waitcnt vmcnt(4)
    s_cmp_eq_u32 s30, 1
    s_cbranch_scc0 K2_W2
    s_waitcnt vmcnt(0)
K2_W2:
    s_barrier
    s_cbranch_scc1 K2_D2
    s_add_u32 s26, s27, s25
    s_add_u32 m0, s24, s33
    s_nop 0
    buffer_load_dwordx4 v1, s[8:11], s26 offen lds
    buffer_load_dwordx4 v1, s[8:11], s26 offen offset:1024 lds
    s_add_u32 s25, s25, 16384
    s_add_u32 s33, s33, 16384
    s_cmp_eq_u32 s33, 81920
    s_cselect_b32 s33, 0, s33
K2_D2:
    ds_read_b128 v[16:19], v145 offset:0
    v_exp_f32 v114, v114
    v_smfmac_f32_16x16x64_bf16 v[44:47], v[40:43], v[96:103], v148
    v_exp_f32 v115, v115
    s_waitcnt lgkmcnt(3)
    v_smfmac_f32_32x32x32_bf16 v[48:63], v[28:31], v[104:111], v148
    v_exp_f32 v116, v116
    v_exp_f32 v117, v117
    ds_read_b128 v[28:31], v146 offset:10752
    v_exp_f32 v118, v118
    s_waitcnt lgkmcnt(3)
    v_mfma_f32_32x32x16_bf16 v[128:143], v[20:23], v[12:15], v[128:143]
    v_exp_f32 v119, v119
    v_exp_f32 v120, v120
    ds_read_b128 v[20:23], v145 offset:512
    v_exp_f32 v121, v121
    v_smfmac_f32_16x16x64_bf16 v[44:47], v[40:43], v[104:111], v148
    v_exp_f32 v122, v122
    s_waitcnt lgkmcnt(3)
    v_smfmac_f32_32x32x32_bf16 v[48:63], v[24:27], v[112:119], v148
    v_exp_f32 v123, v123
    v_exp_f32 v124, v124
    ds_read_b128 v[24:27], v146 offset:14336
    v_exp_f32 v125, v125
    v_exp_f32 v126, v126
    v_exp_f32 v127, v127
    s_waitcnt lgkmcnt(3)
    v_mfma_f32_32x32x16_bf16 v[80:95], v[16:19], v[8:11], v[64:79]
    v_exp_f32 v128, v128
    v_exp_f32 v129, v129
    ds_read_b128 v[16:19], v145 offset:4096
    v_exp_f32 v130, v130
    v_smfmac_f32_16x16x64_bf16 v[44:47], v[40:43], v[112:119], v148
    v_exp_f32 v131, v131
    s_waitcnt lgkmcnt(3)
    v_smfmac_f32_32x32x32_bf16 v[48:63], v[28:31], v[120:127], v148
    v_exp_f32 v132, v132
    v_exp_f32 v133, v133
    ds_read_b128 v[28:31], v146 offset:14848
    v_exp_f32 v134, v134
    s_waitcnt lgkmcnt(3)
    v_mfma_f32_32x32x16_bf16 v[80:95], v[20:23], v[12:15], v[80:95]
    v_exp_f32 v135, v135
    v_exp_f32 v136, v136
    ds_read_b128 v[20:23], v145 offset:4608
    v_exp_f32 v137, v137
    v_smfmac_f32_16x16x64_bf16 v[44:47], v[40:43], v[120:127], v148
    v_exp_f32 v138, v138
    s_waitcnt lgkmcnt(3)
    v_smfmac_f32_32x32x32_bf16 v[48:63], v[24:27], v[128:135], v148
    v_exp_f32 v139, v139
    v_exp_f32 v140, v140
    ds_read_b128 v[24:27], v147 offset:2048
    v_exp_f32 v141, v141
    v_exp_f32 v142, v142
    v_exp_f32 v143, v143
    s_waitcnt lgkmcnt(3)
    v_mfma_f32_32x32x16_bf16 v[96:111], v[16:19], v[8:11], v[64:79]
    v_exp_f32 v80, v80
    v_exp_f32 v81, v81
    ds_read_b128 v[16:19], v145 offset:8192
    v_exp_f32 v82, v82
    v_smfmac_f32_16x16x64_bf16 v[44:47], v[40:43], v[128:135], v148
    v_exp_f32 v83, v83
    s_waitcnt lgkmcnt(3)
    v_smfmac_f32_32x32x32_bf16 v[48:63], v[28:31], v[136:143], v148
    v_exp_f32 v84, v84
    v_exp_f32 v85, v85
    ds_read_b128 v[28:31], v147 offset:2560
    v_exp_f32 v86, v86
    s_waitcnt lgkmcnt(3)
    v_mfma_f32_32x32x16_bf16 v[96:111], v[20:23], v[12:15], v[96:111]
    v_exp_f32 v87, v87
    v_exp_f32 v88, v88
    ds_read_b128 v[20:23], v145 offset:8704
    v_exp_f32 v89, v89
    v_smfmac_f32_16x16x64_bf16 v[44:47], v[40:43], v[136:143], v148
    v_exp_f32 v90, v90
    s_waitcnt lgkmcnt(3)
    v_smfmac_f32_32x32x32_bf16 v[48:63], v[24:27], v[80:87], v148
    v_exp_f32 v91, v91
    v_exp_f32 v92, v92
    ds_read_b128 v[24:27], v147 offset:6144
    v_exp_f32 v93, v93
    v_exp_f32 v94, v94
    v_exp_f32 v95, v95
    s_waitcnt lgkmcnt(3)
    v_mfma_f32_32x32x16_bf16 v[112:127], v[16:19], v[8:11], v[64:79]
    v_exp_f32 v96, v96
    v_exp_f32 v97, v97
    ds_read_b128 v[16:19], v145 offset:12288
    v_exp_f32 v98, v98
    v_smfmac_f32_16x16x64_bf16 v[44:47], v[40:43], v[80:87], v148
    v_exp_f32 v99, v99
    s_waitcnt lgkmcnt(3)
    v_smfmac_f32_32x32x32_bf16 v[48:63], v[28:31], v[88:95], v148
    v_exp_f32 v100, v100
    v_exp_f32 v101, v101
    ds_read_b128 v[28:31], v147 offset:6656
    v_exp_f32 v102, v102
    s_waitcnt lgkmcnt(3)
    v_mfma_f32_32x32x16_bf16 v[112:127], v[20:23], v[12:15], v[112:127]
    v_exp_f32 v103, v103
    v_exp_f32 v104, v104
    ds_read_b128 v[20:23], v145 offset:12800
    v_exp_f32 v105, v105
    v_smfmac_f32_16x16x64_bf16 v[44:47], v[40:43], v[88:95], v148
    v_exp_f32 v106, v106
    s_waitcnt lgkmcnt(3)
    v_smfmac_f32_32x32x32_bf16 v[48:63], v[24:27], v[96:103], v148
    v_exp_f32 v107, v107
    v_exp_f32 v108, v108
    ds_read_b128 v[24:27], v147 offset:10240
    v_exp_f32 v109, v109
    v_exp_f32 v110, v110
    v_exp_f32 v111, v111
    s_waitcnt lgkmcnt(3)
    v_mfma_f32_32x32x16_bf16 v[128:143], v[16:19], v[8:11], v[64:79]
    v_exp_f32 v112, v112
    v_exp_f32 v113, v113
    v_add_u32 v144, s34, v3
    v_add_u32 v146, s34, v2
    s_add_u32 s34, s34, 16384
    s_cmp_eq_u32 s34, 81920
    s_cselect_b32 s34, 0, s34
    s_waitcnt vmcnt(4)
    s_cmp_eq_u32 s30, 1
    s_barrier
    s_cbranch_scc1 K2_D3
    s_add_u32 s26, s27, s25
    s_add_u32 m0, s24, s33
    s_nop 0
    buffer_load_dwordx4 v1, s[8:11], s26 offen lds
    buffer_load_dwordx4 v1, s[8:11], s26 offen offset:1024 lds
    s_add_u32 s25, s25, 16384
    s_add_u32 s33, s33, 16384
    s_cmp_eq_u32 s33, 81920
    s_cselect_b32 s33, 0, s33
K2_D3:
    ds_read_b128 v[16:19], v144 offset:0
    v_exp_f32 v114, v114
    v_smfmac_f32_16x16x64_bf16 v[44:47], v[40:43], v[96:103], v148
    v_exp_f32 v115, v115
    s_waitcnt lgkmcnt(3)
    v_smfmac_f32_32x32x32_bf16 v[48:63], v[28:31], v[104:111], v148
    v_exp_f32 v116, v116
    v_exp_f32 v117, v117
    ds_read_b128 v[28:31], v147 offset:10752
    v_exp_f32 v118, v118
    s_waitcnt lgkmcnt(3)
    v_mfma_f32_32x32x16_bf16 v[128:143], v[20:23], v[12:15], v[128:143]
    v_exp_f32 v119, v119
    v_exp_f32 v120, v120
    ds_read_b128 v[20:23], v144 offset:512
    v_exp_f32 v121, v121
    v_smfmac_f32_16x16x64_bf16 v[44:47], v[40:43], v[104:111], v148
    v_exp_f32 v122, v122
    s_waitcnt lgkmcnt(3)
    v_smfmac_f32_32x32x32_bf16 v[48:63], v[24:27], v[112:119], v148
    v_exp_f32 v123, v123
    v_exp_f32 v124, v124
    ds_read_b128 v[24:27], v147 offset:14336
    v_exp_f32 v125, v125
    v_exp_f32 v126, v126
    v_exp_f32 v127, v127
    s_waitcnt lgkmcnt(3)
    v_mfma_f32_32x32x16_bf16 v[80:95], v[16:19], v[8:11], v[64:79]
    v_exp_f32 v128, v128
    v_exp_f32 v129, v129
    ds_read_b128 v[16:19], v144 offset:4096
    v_exp_f32 v130, v130
    v_smfmac_f32_16x16x64_bf16 v[44:47], v[40:43], v[112:119], v148
    v_exp_f32 v131, v131
    s_waitcnt lgkmcnt(3)
    v_smfmac_f32_32x32x32_bf16 v[48:63], v[28:31], v[120:127], v148
    v_exp_f32 v132, v132
    v_exp_f32 v133, v133
    ds_read_b128 v[28:31], v147 offset:14848
    v_exp_f32 v134, v134
    s_waitcnt lgkmcnt(3)
    v_mfma_f32_32x32x16_bf16 v[80:95], v[20:23], v[12:15], v[80:95]
    v_exp_f32 v135, v135
    v_exp_f32 v136, v136
    ds_read_b128 v[20:23], v144 offset:4608
    v_exp_f32 v137, v137
    v_smfmac_f32_16x16x64_bf16 v[44:47], v[40:43], v[120:127], v148
    v_exp_f32 v138, v138
    s_waitcnt lgkmcnt(3)
    v_smfmac_f32_32x32x32_bf16 v[48:63], v[24:27], v[128:135], v148
    v_exp_f32 v139, v139
    v_exp_f32 v140, v140
    ds_read_b128 v[24:27], v146 offset:2048
    v_exp_f32 v141, v141
    v_exp_f32 v142, v142
    v_exp_f32 v143, v143
    s_sub_u32 s30, s30, 1
    s_cmp_lg_u32 s30, 0
    s_cbranch_scc1 K2_LOOP
K2_DONE:
    s_waitcnt vmcnt(0) lgkmcnt(0)
    v_smfmac_f32_32x32x32_bf16 v[48:63], v[28:31], v[136:143], v148
    v_smfmac_f32_16x16x64_bf16 v[44:47], v[40:43], v[128:135], v148
    v_smfmac_f32_16x16x64_bf16 v[44:47], v[40:43], v[136:143], v148
    s_nop 7
    v_rcp_f32 v4, v44
    s_nop 0
    v_mul_f32 v80, v48, v4
    v_mul_f32 v81, v49, v4
    v_mul_f32 v82, v50, v4
    v_mul_f32 v83, v51, v4
    v_mul_f32 v84, v52, v4
    v_mul_f32 v85, v53, v4
    v_mul_f32 v86, v54, v4
    v_mul_f32 v87, v55, v4
    v_mul_f32 v88, v56, v4
    v_mul_f32 v89, v57, v4
    v_mul_f32 v90, v58, v4
    v_mul_f32 v91, v59, v4
    v_mul_f32 v92, v60, v4
    v_mul_f32 v93, v61, v4
    v_mul_f32 v94, v62, v4
    v_mul_f32 v95, v63, v4
    v_cvt_pk_bf16_f32 v32, v80, v81
    v_cvt_pk_bf16_f32 v33, v82, v83
    v_cvt_pk_bf16_f32 v34, v84, v85
    v_cvt_pk_bf16_f32 v35, v86, v87
    v_cvt_pk_bf16_f32 v36, v88, v89
    v_cvt_pk_bf16_f32 v37, v90, v91
    v_cvt_pk_bf16_f32 v38, v92, v93
    v_cvt_pk_bf16_f32 v39, v94, v95
    buffer_store_dwordx4 v[32:35], v2, s[8:11], s22 offen offset:0 sc1
    buffer_store_dwordx4 v[36:39], v2, s[8:11], s22 offen offset:512 sc1
    s_cmp_lg_u32 s28, 0
    s_cbranch_scc1 K2_END
    v_mov_b32 v5, 0
    v_fmac_f32 v5, 0, v48
    v_fmac_f32 v5, 0, v49
    v_fmac_f32 v5, 0, v50
    v_fmac_f32 v5, 0, v51
    v_fmac_f32 v5, 0, v52
    v_fmac_f32 v5, 0, v53
    v_fmac_f32 v5, 0, v54
    v_fmac_f32 v5, 0, v55
    v_fmac_f32 v5, 0, v56
    v_fmac_f32 v5, 0, v57
    v_fmac_f32 v5, 0, v58
    v_fmac_f32 v5, 0, v59
    v_fmac_f32 v5, 0, v60
    v_fmac_f32 v5, 0, v61
    v_fmac_f32 v5, 0, v62
    v_fmac_f32 v5, 0, v63
    v_mov_b32 v6, 0x21800000
    v_mov_b32 v7, 0x5d800000
    v_cmp_nle_f32 vcc, v6, v44
    v_cmp_nle_f32 s[32:33], v44, v7
    v_cmp_u_f32 s[34:35], v5, v5
    s_or_b64 vcc, vcc, s[32:33]
    s_or_b64 vcc, vcc, s[34:35]
    v_mov_b32 v6, 81920
    s_cbranch_vccz K2_NOFLAG
    v_mov_b32 v7, 1
    ds_write_b32 v6, v7
K2_NOFLAG:
    s_waitcnt lgkmcnt(0)
    s_barrier
    ds_read_b32 v7, v6
    s_waitcnt lgkmcnt(0)
    v_readfirstlane_b32 s31, v7
    s_nop 0
    s_cmp_eq_u32 s31, 0
    s_cbranch_scc1 K2_END
    s_mov_b32 s28, 1
    s_mov_b32 s29, s23
    s_mov_b32 s30, 64
    v_mov_b32 v4, 0xff800000
K2_MAXLOOP:
    buffer_load_dwordx4 v[16:19], v3, s[8:11], s29 offen offset:0
    buffer_load_dwordx4 v[20:23], v3, s[8:11], s29 offen offset:512
    s_add_u32 s29, s29, 4096
    s_waitcnt vmcnt(0)
    v_mfma_f32_32x32x16_bf16 v[80:95], v[16:19], v[8:11], 0
    v_mfma_f32_32x32x16_bf16 v[80:95], v[20:23], v[12:15], v[80:95]
    s_nop 11
    v_max3_f32 v4, v4, v80, v81
    v_max3_f32 v4, v4, v82, v83
    v_max3_f32 v4, v4, v84, v85
    v_max3_f32 v4, v4, v86, v87
    v_max3_f32 v4, v4, v88, v89
    v_max3_f32 v4, v4, v90, v91
    v_max3_f32 v4, v4, v92, v93
    v_max3_f32 v4, v4, v94, v95
    s_sub_u32 s30, s30, 1
    s_cmp_lg_u32 s30, 0
    s_cbranch_scc1 K2_MAXLOOP
    v_mov_b32 v5, v4
    s_nop 1
    v_permlane32_swap_b32 v4, v5
    v_max_f32 v4, v4, v5
    v_sub_f32 v64, 0, v4
    v_sub_f32 v65, 0, v4
    v_sub_f32 v66, 0, v4
    v_sub_f32 v67, 0, v4
    v_sub_f32 v68, 0, v4
    v_sub_f32 v69, 0, v4
    v_sub_f32 v70, 0, v4
    v_sub_f32 v71, 0, v4
    v_sub_f32 v72, 0, v4
    v_sub_f32 v73, 0, v4
    v_sub_f32 v74, 0, v4
    v_sub_f32 v75, 0, v4
    v_sub_f32 v76, 0, v4
    v_sub_f32 v77, 0, v4
    v_sub_f32 v78, 0, v4
    v_sub_f32 v79, 0, v4
    s_branch K2_RUN
K2_END:
    s_endpgm
K2_XEND:
K2_PACK:
    s_load_dwordx2 s[60:61], s[0:1], 72
    s_load_dwordx2 s[62:63], s[0:1], 32
    s_load_dwordx2 s[64:65], s[0:1], 40
    s_load_dwordx2 s[66:67], s[0:1], 48
    s_load_dwordx2 s[68:69], s[0:1], 16
    s_load_dwordx2 s[70:71], s[0:1], 0
    s_waitcnt lgkmcnt(0)
    s_mov_b32 s8, s60
    s_mov_b32 s9, s61
    s_mov_b32 s10, 0x10000000
    s_mov_b32 s11, 0x00020000
    s_mov_b32 s12, s62
    s_mov_b32 s13, s63
    s_mov_b32 s14, 0x700000
    s_mov_b32 s15, 0x00020000
    s_mov_b32 s16, s64
    s_mov_b32 s17, s65
    s_mov_b32 s18, 0x700000
    s_mov_b32 s19, 0x00020000
    s_mov_b32 s20, s66
    s_mov_b32 s21, s67
    s_mov_b32 s22, 0x700000
    s_mov_b32 s23, 0x00020000
    s_mov_b32 s24, s68
    s_mov_b32 s25, s69
    s_mov_b32 s26, 0x200000
    s_mov_b32 s27, 0x00020000
    s_mov_b32 s56, s70
    s_mov_b32 s57, s71
    s_mov_b32 s58, 0x400000
    s_mov_b32 s59, 0x00020000
    s_sub_u32 s3, s3, 8
    s_lshr_b32 s28, s2, 2
    s_and_b32 s29, s3, 1
    s_lshl_b32 s30, s28, 1
    s_add_u32 s30, s30, s29
    s_and_b32 s31, s2, 3
    s_lshl_b32 s31, s31, 1
    s_lshr_b32 s32, s3, 1
    s_add_u32 s31, s31, s32
    s_lshl_b32 s32, s31, 2
    v_lshrrev_b32 v1, 2, v0
    s_movk_i32 s33, 7168
    v_mul_lo_u32 v1, v1, s33
    v_bfe_u32 v2, v0, 4, 1
    v_lshlrev_b32 v2, 1, v2
    v_and_b32 v3, 3, v0
    v_xor_b32 v2, v2, v3
    v_lshl_add_u32 v1, v2, 4, v1
    v_add_u32 v2, 113664, v1
    s_mul_i32 s34, s32, 229376
    s_lshl_b32 s33, s30, 6
    s_add_u32 s34, s34, s33
    s_lshl_b32 s35, s3, 14
    s_add_u32 s35, s35, 82176
    s_mul_i32 s37, s30, 9363
    s_lshr_b32 s37, s37, 16
    s_mul_i32 s38, s37, 7
    s_sub_u32 s38, s30, s38
    s_lshl_b32 s39, s37, 1
    s_cmp_ge_u32 s38, 4
    s_cselect_b32 s40, 1, 0
    s_add_u32 s40, s39, s40
    s_cmp_ge_u32 s38, 4
    s_cselect_b32 s41, 4, 0
    s_sub_u32 s41, s38, s41
    s_lshl_b32 s41, s41, 2
    s_add_u32 s42, s41, 2
    s_mov_b32 s43, s40
    s_cmp_eq_u32 s38, 3
    s_cselect_b32 s42, 12, s42
    s_add_u32 s44, s39, 1
    s_cmp_eq_u32 s38, 3
    s_cselect_b32 s43, s44, s43
    s_mul_i32 s45, s32, 14
    s_mul_i32 s44, s40, 448
    s_add_u32 s44, s44, s41
    s_add_u32 s44, s44, s45
    s_lshl_b32 s44, s44, 10
    s_add_u32 s46, s44, 26214400
    s_mul_i32 s44, s43, 448
    s_add_u32 s44, s44, s42
    s_add_u32 s44, s44, s45
    s_lshl_b32 s44, s44, 10
    s_add_u32 s47, s44, 26214400
    s_mul_i32 s45, s31, 448
    s_mul_i32 s44, s40, 14
    s_add_u32 s44, s44, s41
    s_add_u32 s44, s44, s45
    s_lshl_b32 s44, s44, 6
    s_add_u32 s48, s44, 25690112
    s_mul_i32 s44, s43, 14
    s_add_u32 s44, s44, s42
    s_add_u32 s44, s44, s45
    s_lshl_b32 s44, s44, 6
    s_add_u32 s49, s44, 25690112
    v_lshrrev_b32 v3, 2, v0
    v_lshlrev_b32 v3, 6, v3
    v_bfe_u32 v4, v0, 4, 1
    v_lshlrev_b32 v4, 1, v4
    v_bfe_u32 v5, v0, 1, 1
    v_xor_b32 v4, v4, v5
    v_lshl_add_u32 v3, v4, 4, v3
    v_and_b32 v4, 1, v0
    v_lshl_add_u32 v3, v4, 3, v3
    v_xor_b32 v4, 32, v3
    v_add_u32 v3, s35, v3
    v_add_u32 v4, s35, v4
    v_lshlrev_b32 v5, 4, v0
    v_and_b32 v6, 15, v0
    v_cmp_eq_u32 vcc, 0, v6
    v_lshrrev_b32 v6, 4, v0
    v_lshlrev_b32 v6, 4, v6
    v_mov_b32 v7, 0x7fff0000
    v_cndmask_b32 v6, v7, v6, vcc
    v_mov_b32 v8, 0x3f803f80
    v_mov_b32 v9, 0x3f803f80
    v_mov_b32 v10, 0x3f803f80
    v_mov_b32 v11, 0x3f803f80
    v_mov_b32 v12, 0
    v_mov_b32 v13, 0
    v_mov_b32 v14, 0
    v_mov_b32 v15, 0
    v_mov_b32 v16, 0
    v_mov_b32 v17, 0
    v_mov_b32 v18, 0
    v_mov_b32 v19, 0
    v_mov_b32 v20, 0
    v_mov_b32 v21, 0
    v_mov_b32 v22, 0
    v_mov_b32 v23, 0
    v_mov_b32 v24, 0
    v_mov_b32 v25, 0
    v_mov_b32 v26, 0
    v_mov_b32 v27, 0
    s_mul_i32 s50, s2, 224
    s_mul_i32 s51, s3, 56
    s_add_u32 s50, s50, s51
    v_add_u32 v44, s50, v0
    v_lshlrev_b32 v44, 7, v44
    s_lshr_b32 s50, s2, 3
    s_lshl_b32 s50, s50, 5
    s_lshl_b32 s51, s3, 3
    s_add_u32 s50, s50, s51
    v_lshrrev_b32 v45, 3, v0
    v_add_u32 v45, s50, v45
    v_lshlrev_b32 v45, 11, v45
    v_and_b32 v46, 7, v0
    v_lshl_add_u32 v45, v46, 7, v45
    s_and_b32 s50, s2, 1
    s_lshl_b32 s50, s50, 10
    s_and_b32 s53, s2, 7
    s_lshr_b32 s53, s53, 1
    s_lshl_b32 s53, s53, 9
    s_lshr_b32 s54, s2, 3
    s_lshl_b32 s54, s54, 4
    s_add_u32 s53, s53, s54
    s_lshl_b32 s54, s3, 2
    s_add_u32 s53, s53, s54
    s_lshl_b32 s53, s53, 11
    s_add_u32 s53, s53, s50
    v_bfe_u32 v49, v0, 3, 2
    v_lshlrev_b32 v49, 11, v49
    v_lshl_add_u32 v49, v46, 7, v49
    s_cmp_lt_u32 s2, 224
    s_cselect_b32 s52, 1, 0
    v_lshrrev_b32 v56, 2, v0
    v_lshlrev_b32 v56, 11, v56
    v_bfe_u32 v57, v0, 4, 1
    v_lshlrev_b32 v57, 1, v57
    v_and_b32 v58, 3, v0
    v_xor_b32 v57, v57, v58
    v_lshl_add_u32 v56, v57, 4, v56
    v_add_u32 v57, 31744, v56
    s_lshl_b32 s61, s2, 2
    s_add_u32 s61, s61, s3
    s_lshr_b32 s62, s61, 4
    s_and_b32 s61, s61, 15
    s_lshr_b32 s63, s61, 1
    s_mul_i32 s63, s63, 112
    s_lshl_b32 s44, s62, 1
    s_add_u32 s63, s63, s44
    s_lshl_b32 s63, s63, 13
    s_and_b32 s44, s61, 1
    s_lshl_b32 s44, s44, 12
    s_add_u32 s63, s63, s44
    s_lshl_b32 s44, s62, 17
    s_lshl_b32 s61, s61, 7
    s_add_u32 s61, s61, s44
    s_add_u32 s62, s63, 50331648
    s_add_u32 s63, s61, 64
    s_lshl_b32 s55, s2, 2
    s_add_u32 s55, s55, s3
    s_lshl_b32 s55, s55, 12
    s_add_u32 s55, s55, 41943040
    v_mov_b32 v52, -1
    v_mov_b32 v53, -1
    v_mov_b32 v54, -1
    v_mov_b32 v55, -1
    s_barrier
    s_barrier
    s_cmp_eq_u32 s52, 0
    s_cbranch_scc1 K2_PK_0
    s_add_u32 m0, s35, 0
    s_nop 0
    buffer_load_dwordx4 v1, s[12:15], s34 offen lds
    buffer_load_dwordx4 v2, s[12:15], s34 offen offset:1024 lds
    s_add_u32 m0, s35, 2048
    s_nop 0
    buffer_load_dwordx4 v1, s[16:19], s34 offen lds
    buffer_load_dwordx4 v2, s[16:19], s34 offen offset:1024 lds
    s_add_u32 s34, s34, 229376
K2_PK_0:
    s_barrier
    s_barrier
    s_cmp_eq_u32 s52, 0
    s_cbranch_scc1 K2_PK_1
    s_add_u32 m0, s35, 4096
    s_nop 0
    buffer_load_dwordx4 v1, s[12:15], s34 offen lds
    buffer_load_dwordx4 v2, s[12:15], s34 offen offset:1024 lds
    s_add_u32 m0, s35, 6144
    s_nop 0
    buffer_load_dwordx4 v1, s[16:19], s34 offen lds
    buffer_load_dwordx4 v2, s[16:19], s34 offen offset:1024 lds
    s_add_u32 s34, s34, 229376
K2_PK_1:
    s_barrier
    s_cmp_eq_u32 s52, 0
    s_cbranch_scc1 K2_PK_2
    s_waitcnt vmcnt(4)
    ds_read_b64_tr_b16 v[28:29], v3 offset:0
    ds_read_b64_tr_b16 v[30:31], v3 offset:1024
    ds_read_b64_tr_b16 v[32:33], v3 offset:2048
    ds_read_b64_tr_b16 v[34:35], v3 offset:3072
    ds_read_b64_tr_b16 v[36:37], v4 offset:0
    ds_read_b64_tr_b16 v[38:39], v4 offset:1024
    ds_read_b64_tr_b16 v[40:41], v4 offset:2048
    ds_read_b64_tr_b16 v[42:43], v4 offset:3072
    s_waitcnt lgkmcnt(4)
    buffer_store_dwordx4 v[28:31], v5, s[8:11], s46 offen offset:0 sc1
    buffer_store_dwordx4 v[32:35], v5, s[8:11], s46 offen offset:1024 sc1
    v_mfma_f32_16x16x32_bf16 v[12:15], v[28:31], v[8:11], v[12:15]
    v_mfma_f32_16x16x32_bf16 v[16:19], v[32:35], v[8:11], v[16:19]
    s_add_u32 s46, s46, 14336
    s_waitcnt lgkmcnt(0)
    buffer_store_dwordx4 v[36:39], v5, s[8:11], s47 offen offset:0 sc1
    buffer_store_dwordx4 v[40:43], v5, s[8:11], s47 offen offset:1024 sc1
    v_mfma_f32_16x16x32_bf16 v[20:23], v[36:39], v[8:11], v[20:23]
    v_mfma_f32_16x16x32_bf16 v[24:27], v[40:43], v[8:11], v[24:27]
    s_add_u32 s47, s47, 14336
K2_PK_2:
    s_barrier
    s_cmp_eq_u32 s52, 0
    s_cbranch_scc1 K2_PK_3
    s_add_u32 m0, s35, 8192
    s_nop 0
    buffer_load_dwordx4 v1, s[12:15], s34 offen lds
    buffer_load_dwordx4 v2, s[12:15], s34 offen offset:1024 lds
    s_add_u32 m0, s35, 10240
    s_nop 0
    buffer_load_dwordx4 v1, s[16:19], s34 offen lds
    buffer_load_dwordx4 v2, s[16:19], s34 offen offset:1024 lds
    s_add_u32 s34, s34, 229376
K2_PK_3:
    s_barrier
    s_cmp_eq_u32 s52, 0
    s_cbranch_scc1 K2_PK_4
    s_waitcnt vmcnt(8)
    ds_read_b64_tr_b16 v[28:29], v3 offset:4096
    ds_read_b64_tr_b16 v[30:31], v3 offset:5120
    ds_read_b64_tr_b16 v[32:33], v3 offset:6144
    ds_read_b64_tr_b16 v[34:35], v3 offset:7168
    ds_read_b64_tr_b16 v[36:37], v4 offset:4096
    ds_read_b64_tr_b16 v[38:39], v4 offset:5120
    ds_read_b64_tr_b16 v[40:41], v4 offset:6144
    ds_read_b64_tr_b16 v[42:43], v4 offset:7168
    s_waitcnt lgkmcnt(4)
    buffer_store_dwordx4 v[28:31], v5, s[8:11], s46 offen offset:0 sc1
    buffer_store_dwordx4 v[32:35], v5, s[8:11], s46 offen offset:1024 sc1
    v_mfma_f32_16x16x32_bf16 v[12:15], v[28:31], v[8:11], v[12:15]
    v_mfma_f32_16x16x32_bf16 v[16:19], v[32:35], v[8:11], v[16:19]
    s_add_u32 s46, s46, 14336
    s_waitcnt lgkmcnt(0)
    buffer_store_dwordx4 v[36:39], v5, s[8:11], s47 offen offset:0 sc1
    buffer_store_dwordx4 v[40:43], v5, s[8:11], s47 offen offset:1024 sc1
    v_mfma_f32_16x16x32_bf16 v[20:23], v[36:39], v[8:11], v[20:23]
    v_mfma_f32_16x16x32_bf16 v[24:27], v[40:43], v[8:11], v[24:27]
    s_add_u32 s47, s47, 14336
K2_PK_4:
    s_barrier
    s_cmp_eq_u32 s52, 0
    s_cbranch_scc1 K2_PK_5
    s_add_u32 m0, s35, 12288
    s_nop 0
    buffer_load_dwordx4 v1, s[12:15], s34 offen lds
    buffer_load_dwordx4 v2, s[12:15], s34 offen offset:1024 lds
    s_add_u32 m0, s35, 14336
    s_nop 0
    buffer_load_dwordx4 v1, s[16:19], s34 offen lds
    buffer_load_dwordx4 v2, s[16:19], s34 offen offset:1024 lds
    s_add_u32 s34, s34, 229376
K2_PK_5:
    s_barrier
    s_cmp_eq_u32 s52, 0
    s_cbranch_scc1 K2_PK_6
    s_waitcnt vmcnt(8)
    ds_read_b64_tr_b16 v[28:29], v3 offset:8192
    ds_read_b64_tr_b16 v[30:31], v3 offset:9216
    ds_read_b64_tr_b16 v[32:33], v3 offset:10240
    ds_read_b64_tr_b16 v[34:35], v3 offset:11264
    ds_read_b64_tr_b16 v[36:37], v4 offset:8192
    ds_read_b64_tr_b16 v[38:39], v4 offset:9216
    ds_read_b64_tr_b16 v[40:41], v4 offset:10240
    ds_read_b64_tr_b16 v[42:43], v4 offset:11264
    s_waitcnt lgkmcnt(4)
    buffer_store_dwordx4 v[28:31], v5, s[8:11], s46 offen offset:0 sc1
    buffer_store_dwordx4 v[32:35], v5, s[8:11], s46 offen offset:1024 sc1
    v_mfma_f32_16x16x32_bf16 v[12:15], v[28:31], v[8:11], v[12:15]
    v_mfma_f32_16x16x32_bf16 v[16:19], v[32:35], v[8:11], v[16:19]
    s_add_u32 s46, s46, 14336
    s_waitcnt lgkmcnt(0)
    buffer_store_dwordx4 v[36:39], v5, s[8:11], s47 offen offset:0 sc1
    buffer_store_dwordx4 v[40:43], v5, s[8:11], s47 offen offset:1024 sc1
    v_mfma_f32_16x16x32_bf16 v[20:23], v[36:39], v[8:11], v[20:23]
    v_mfma_f32_16x16x32_bf16 v[24:27], v[40:43], v[8:11], v[24:27]
    s_add_u32 s47, s47, 14336
K2_PK_6:
    s_barrier
    s_cmp_eq_u32 s52, 0
    s_cbranch_scc1 K2_PK_7
    s_add_u32 m0, s35, 0
    s_nop 0
    buffer_load_dwordx4 v56, s[20:23], s61 offen lds
    buffer_load_dwordx4 v57, s[20:23], s61 offen offset:1024 lds
    s_add_u32 m0, s35, 2048
    s_nop 0
    buffer_load_dwordx4 v56, s[20:23], s63 offen lds
    buffer_load_dwordx4 v57, s[20:23], s63 offen offset:1024 lds
    s_add_u32 s61, s61, 65536
    s_add_u32 s63, s63, 65536
K2_PK_7:
    s_barrier
    s_cmp_eq_u32 s52, 0
    s_cbranch_scc1 K2_PK_8
    s_waitcnt vmcnt(8)
    ds_read_b64_tr_b16 v[28:29], v3 offset:12288
    ds_read_b64_tr_b16 v[30:31], v3 offset:13312
    ds_read_b64_tr_b16 v[32:33], v3 offset:14336
    ds_read_b64_tr_b16 v[34:35], v3 offset:15360
    ds_read_b64_tr_b16 v[36:37], v4 offset:12288
    ds_read_b64_tr_b16 v[38:39], v4 offset:13312
    ds_read_b64_tr_b16 v[40:41], v4 offset:14336
    ds_read_b64_tr_b16 v[42:43], v4 offset:15360
    s_waitcnt lgkmcnt(4)
    buffer_store_dwordx4 v[28:31], v5, s[8:11], s46 offen offset:0 sc1
    buffer_store_dwordx4 v[32:35], v5, s[8:11], s46 offen offset:1024 sc1
    v_mfma_f32_16x16x32_bf16 v[12:15], v[28:31], v[8:11], v[12:15]
    v_mfma_f32_16x16x32_bf16 v[16:19], v[32:35], v[8:11], v[16:19]
    s_add_u32 s46, s46, 14336
    s_waitcnt lgkmcnt(0)
    buffer_store_dwordx4 v[36:39], v5, s[8:11], s47 offen offset:0 sc1
    buffer_store_dwordx4 v[40:43], v5, s[8:11], s47 offen offset:1024 sc1
    v_mfma_f32_16x16x32_bf16 v[20:23], v[36:39], v[8:11], v[20:23]
    v_mfma_f32_16x16x32_bf16 v[24:27], v[40:43], v[8:11], v[24:27]
    s_add_u32 s47, s47, 14336
K2_PK_8:
    s_cmp_eq_u32 s52, 0
    s_cbranch_scc1 K2_PK_9
    buffer_store_dwordx4 v[12:15], v6, s[8:11], s48 offen offset:0 sc1
    buffer_store_dwordx4 v[16:19], v6, s[8:11], s48 offen offset:64 sc1
    s_nop 1
    buffer_store_dwordx4 v[20:23], v6, s[8:11], s49 offen offset:0 sc1
    buffer_store_dwordx4 v[24:27], v6, s[8:11], s49 offen offset:64 sc1
K2_PK_9:
    s_barrier
    s_cmp_eq_u32 s52, 0
    s_cbranch_scc1 K2_PK_10
    s_add_u32 m0, s35, 4096
    s_nop 0
    buffer_load_dwordx4 v56, s[20:23], s61 offen lds
    buffer_load_dwordx4 v57, s[20:23], s61 offen offset:1024 lds
    s_add_u32 m0, s35, 6144
    s_nop 0
    buffer_load_dwordx4 v56, s[20:23], s63 offen lds
    buffer_load_dwordx4 v57, s[20:23], s63 offen offset:1024 lds
    s_add_u32 s61, s61, 65536
    s_add_u32 s63, s63, 65536
K2_PK_10:
    s_barrier
    buffer_store_dwordx4 v[52:55], v5, s[8:11], s55 offen offset:0 sc1
    buffer_store_dwordx4 v[52:55], v5, s[8:11], s55 offen offset:1024 sc1
    buffer_store_dwordx4 v[52:55], v5, s[8:11], s55 offen offset:2048 sc1
    buffer_store_dwordx4 v[52:55], v5, s[8:11], s55 offen offset:3072 sc1
    s_cmp_eq_u32 s52, 0
    s_cbranch_scc1 K2_PK_11
    s_waitcnt vmcnt(16)
    ds_read_b64_tr_b16 v[28:29], v3 offset:0
    ds_read_b64_tr_b16 v[30:31], v3 offset:1024
    ds_read_b64_tr_b16 v[32:33], v3 offset:2048
    ds_read_b64_tr_b16 v[34:35], v3 offset:3072
    ds_read_b64_tr_b16 v[36:37], v4 offset:0
    ds_read_b64_tr_b16 v[38:39], v4 offset:1024
    ds_read_b64_tr_b16 v[40:41], v4 offset:2048
    ds_read_b64_tr_b16 v[42:43], v4 offset:3072
    s_waitcnt lgkmcnt(4)
    buffer_store_dwordx4 v[28:31], v5, s[8:11], s62 offen offset:0 sc1
    buffer_store_dwordx4 v[32:35], v5, s[8:11], s62 offen offset:2048 sc1
    s_waitcnt lgkmcnt(0)
    buffer_store_dwordx4 v[36:39], v5, s[8:11], s62 offen offset:1024 sc1
    buffer_store_dwordx4 v[40:43], v5, s[8:11], s62 offen offset:3072 sc1
    s_add_u32 s62, s62, 8192
K2_PK_11:
    s_barrier
    buffer_load_dword v48, v45, s[24:27], s50 offen
    s_barrier
    s_cmp_eq_u32 s52, 0
    s_cbranch_scc1 K2_PK_12
    s_waitcnt vmcnt(9)
    ds_read_b64_tr_b16 v[28:29], v3 offset:4096
    ds_read_b64_tr_b16 v[30:31], v3 offset:5120
    ds_read_b64_tr_b16 v[32:33], v3 offset:6144
    ds_read_b64_tr_b16 v[34:35], v3 offset:7168
    ds_read_b64_tr_b16 v[36:37], v4 offset:4096
    ds_read_b64_tr_b16 v[38:39], v4 offset:5120
    ds_read_b64_tr_b16 v[40:41], v4 offset:6144
    ds_read_b64_tr_b16 v[42:43], v4 offset:7168
    s_waitcnt lgkmcnt(4)
    buffer_store_dwordx4 v[28:31], v5, s[8:11], s62 offen offset:0 sc1
    buffer_store_dwordx4 v[32:35], v5, s[8:11], s62 offen offset:2048 sc1
    s_waitcnt lgkmcnt(0)
    buffer_store_dwordx4 v[36:39], v5, s[8:11], s62 offen offset:1024 sc1
    buffer_store_dwordx4 v[40:43], v5, s[8:11], s62 offen offset:3072 sc1
    s_add_u32 s62, s62, 8192
K2_PK_12:
    buffer_load_dword v50, v49, s[56:59], s53 offen
    s_barrier
    s_cmp_lg_u32 s3, 0
    s_cbranch_scc1 CPF6_X
    v_min_u32 v2, 2, v0
    s_lshr_b32 s62, s2, 3
    s_mul_i32 s62, s62, 384
    v_lshl_add_u32 v2, v2, 7, s62
    v_min_u32 v2, TEXT_END-K2_DONE-4, v2
    s_getpc_b64 s[62:63]
CPF6:
    s_sub_u32 s62, s62, CPF6-K2_DONE
    s_subb_u32 s63, s63, 0
    v_mov_b32 v3, s63
    v_add_co_u32 v2, vcc, s62, v2
    s_nop 1
    v_addc_co_u32 v3, vcc, 0, v3, vcc
    global_load_dword v4, v[2:3], off
CPF6_X:
    s_endpgm
.globl wo_kernel
.p2align 8
.type wo_kernel,@function
wo_kernel:
    s_cmp_ge_u32 s2, 256
    s_cbranch_scc1 K3_END
    s_load_dwordx2 s[40:41], s[0:1], 16
    s_load_dwordx2 s[42:43], s[0:1], 72
    s_load_dwordx2 s[44:45], s[0:1], 0
    v_lshrrev_b32 v1, 6, v0
    v_and_b32 v0, 63, v0
    v_readfirstlane_b32 s3, v1
    s_nop 0
    s_cmp_lg_u32 s3, 0
    s_cbranch_scc1 CPF8_X
    v_min_u32 v2, 5, v0
    s_lshr_b32 s62, s2, 3
    s_mul_i32 s62, s62, 768
    v_lshl_add_u32 v2, v2, 7, s62
    v_min_u32 v2, TEXT_END-CPF8-4, v2
    s_getpc_b64 s[62:63]
CPF8:
    v_mov_b32 v3, s63
    v_add_co_u32 v2, vcc, s62, v2
    s_nop 1
    v_addc_co_u32 v3, vcc, 0, v3, vcc
    global_load_dword v23, v[2:3], off
CPF8_X:
    s_and_b32 s16, s2, 7
    s_lshr_b32 s17, s2, 3
    s_lshr_b32 s18, s16, 1
    s_lshl_b32 s18, s18, 2
    s_and_b32 s19, s17, 3
    s_add_u32 s18, s18, s19
    s_and_b32 s19, s16, 1
    s_lshl_b32 s19, s19, 3
    s_lshr_b32 s20, s17, 2
    s_add_u32 s19, s19, s20
    s_lshl_b32 s24, s3, 7
    s_lshl_b32 s25, s18, 3
    s_add_u32 s24, s24, s25
    s_lshl_b32 s24, s24, 10
    s_add_u32 s24, s24, 16777216
    s_lshl_b32 s25, s3, 16
    s_lshl_b32 s26, s19, 7
    s_add_u32 s25, s25, s26
    s_lshl_b32 s26, s3, 13
    s_lshl_b32 s27, s3, 12
    s_add_u32 s27, s27, 32768
    v_lshlrev_b32 v1, 4, v0
    v_lshrrev_b32 v6, 3, v0
    v_lshlrev_b32 v6, 11, v6
    v_bfe_u32 v8, v0, 1, 2
    v_and_b32 v9, 1, v0
    v_lshl_add_u32 v6, v9, 4, v6
    v_bfe_u32 v7, v0, 4, 2
    v_xor_b32 v7, v7, v8
    v_lshl_add_u32 v7, v7, 5, v6
    v_add_u32 v2, 0, v7
    v_bfe_u32 v7, v0, 4, 2
    v_xor_b32 v7, v7, v8
    v_lshl_add_u32 v7, v7, 5, v6
    v_add_u32 v3, 15360, v7
    v_bfe_u32 v7, v0, 4, 2
    v_xor_b32 v7, v7, v8
    v_lshl_add_u32 v7, v7, 5, v6
    v_add_u32 v4, 30720, v7
    v_bfe_u32 v7, v0, 4, 2
    v_xor_b32 v7, v7, v8
    v_lshl_add_u32 v7, v7, 5, v6
    v_add_u32 v5, 46080, v7
    s_waitcnt lgkmcnt(0)
    s_mov_b32 s4, s40
    s_mov_b32 s5, s41
    s_mov_b32 s6, 0x200000
    s_mov_b32 s7, 0x00020000
    s_mov_b32 s8, s42
    s_mov_b32 s9, s43
    s_mov_b32 s10, 0x10000000
    s_mov_b32 s11, 0x00020000
    s_mov_b32 s12, s44
    s_mov_b32 s13, s45
    s_mov_b32 s14, 0x400000
    s_mov_b32 s15, 0x00020000
    s_add_u32 m0, s26, 0
    s_nop 0
    buffer_load_dwordx4 v1, s[8:11], s24 offen offset:0 lds
    buffer_load_dwordx4 v1, s[8:11], s24 offen offset:1024 lds
    buffer_load_dwordx4 v1, s[8:11], s24 offen offset:2048 lds
    buffer_load_dwordx4 v1, s[8:11], s24 offen offset:3072 lds
    s_add_u32 m0, s26, 4096
    s_add_u32 s28, s24, 4096
    buffer_load_dwordx4 v1, s[8:11], s28 offen offset:0 lds
    buffer_load_dwordx4 v1, s[8:11], s28 offen offset:1024 lds
    buffer_load_dwordx4 v1, s[8:11], s28 offen offset:2048 lds
    buffer_load_dwordx4 v1, s[8:11], s28 offen offset:3072 lds
    s_add_u32 s24, s24, 524288
    s_add_u32 m0, s27, 0
    s_nop 0
    buffer_load_dwordx4 v2, s[4:7], s25 offen offset:0 lds
    buffer_load_dwordx4 v3, s[4:7], s25 offen offset:1024 lds
    buffer_load_dwordx4 v4, s[4:7], s25 offen offset:2048 lds
    buffer_load_dwordx4 v5, s[4:7], s25 offen offset:3072 lds
    s_add_u32 s25, s25, 262144
    s_lshl_b32 s29, s3, 11
    v_add_u32 v6, s29, v1
    v_add_u32 v7, 49152, v6
    v_add_u32 v8, 98304, v6
    v_lshrrev_b32 v28, 4, v0
    v_bfe_u32 v30, v0, 2, 2
    v_lshrrev_b32 v29, 1, v28
    v_lshlrev_b32 v29, 11, v29
    v_and_b32 v31, 1, v28
    v_lshl_add_u32 v29, v31, 9, v29
    v_lshl_add_u32 v29, v30, 7, v29
    v_and_b32 v31, 3, v0
    v_lshl_add_u32 v29, v31, 3, v29
    v_add_u32 v29, 32768, v29
    v_lshrrev_b32 v30, 1, v30
    v_and_b32 v28, 1, v28
    v_lshl_add_u32 v30, v28, 1, v30
    v_xor_b32 v31, 0, v30
    v_lshl_add_u32 v9, v31, 5, v29
    v_add_u32 v13, 49152, v9
    v_add_u32 v17, 98304, v9
    v_xor_b32 v31, 1, v30
    v_lshl_add_u32 v10, v31, 5, v29
    v_add_u32 v14, 49152, v10
    v_add_u32 v18, 98304, v10
    v_xor_b32 v31, 2, v30
    v_lshl_add_u32 v11, v31, 5, v29
    v_add_u32 v15, 49152, v11
    v_add_u32 v19, 98304, v11
    v_xor_b32 v31, 3, v30
    v_lshl_add_u32 v12, v31, 5, v29
    v_add_u32 v16, 49152, v12
    v_add_u32 v20, 98304, v12
    s_lshl_b32 s32, s18, 3
    s_lshl_b32 s33, s3, 1
    s_add_u32 s32, s32, s33
    s_lshl_b32 s34, s32, 15
    s_lshl_b32 s35, s19, 7
    s_add_u32 s34, s34, s35
    s_lshl_b32 s35, s19, 8
    s_add_u32 s35, s35, s32
    s_lshl_b32 s35, s35, 10
    s_add_u32 s35, s35, 20971520
    s_add_u32 s36, s35, 0x20000
    v_and_b32 v28, 15, v0
    v_lshlrev_b32 v28, 11, v28
    v_lshrrev_b32 v29, 4, v0
    v_lshl_add_u32 v28, v29, 3, v28
    s_add_u32 s37, s34, 0x8000
    s_lshr_b32 s38, s16, 1
    s_lshl_b32 s38, s38, 3
    s_lshr_b32 s39, s17, 2
    s_add_u32 s38, s38, s39
    s_mul_i32 s38, s38, 458752
    s_add_u32 s38, s38, 26214400
    s_and_b32 s39, s17, 3
    s_lshl_b32 s39, s39, 2
    s_add_u32 s39, s39, s3
    s_mul_i32 s39, s39, 4480
    s_add_u32 s38, s38, s39
    v_lshlrev_b32 v21, 7, v0
    v_mov_b64 v[32:33], 0
    v_mov_b64 v[34:35], 0
    v_mov_b64 v[36:37], 0
    v_mov_b64 v[38:39], 0
    v_mov_b64 v[40:41], 0
    v_mov_b64 v[42:43], 0
    v_mov_b64 v[44:45], 0
    v_mov_b64 v[46:47], 0
    v_mov_b64 v[48:49], 0
    v_mov_b64 v[50:51], 0
    v_mov_b64 v[52:53], 0
    v_mov_b64 v[54:55], 0
    v_mov_b64 v[56:57], 0
    v_mov_b64 v[58:59], 0
    v_mov_b64 v[60:61], 0
    v_mov_b64 v[62:63], 0
    s_add_u32 m0, s26, 49152
    s_nop 0
    buffer_load_dwordx4 v1, s[8:11], s24 offen offset:0 lds
    buffer_load_dwordx4 v1, s[8:11], s24 offen offset:1024 lds
    buffer_load_dwordx4 v1, s[8:11], s24 offen offset:2048 lds
    buffer_load_dwordx4 v1, s[8:11], s24 offen offset:3072 lds
    s_add_u32 m0, s26, 53248
    s_add_u32 s28, s24, 4096
    buffer_load_dwordx4 v1, s[8:11], s28 offen offset:0 lds
    buffer_load_dwordx4 v1, s[8:11], s28 offen offset:1024 lds
    buffer_load_dwordx4 v1, s[8:11], s28 offen offset:2048 lds
    buffer_load_dwordx4 v1, s[8:11], s28 offen offset:3072 lds
    s_add_u32 s24, s24, 524288
    s_add_u32 m0, s27, 49152
    s_nop 0
    buffer_load_dwordx4 v2, s[4:7], s25 offen offset:0 lds
    buffer_load_dwordx4 v3, s[4:7], s25 offen offset:1024 lds
    buffer_load_dwordx4 v4, s[4:7], s25 offen offset:2048 lds
    buffer_load_dwordx4 v5, s[4:7], s25 offen offset:3072 lds
    s_add_u32 s25, s25, 262144
    s_waitcnt vmcnt(12)
    s_barrier
    ds_read_b128 v[96:99], v6 offset:0
    ds_read_b128 v[100:103], v6 offset:1024
    ds_read_b64_tr_b16 v[64:65], v9 offset:0
    ds_read_b64_tr_b16 v[66:67], v9 offset:1024
    ds_read_b64_tr_b16 v[68:69], v10 offset:0
    ds_read_b64_tr_b16 v[70:71], v10 offset:1024
    ds_read_b64_tr_b16 v[72:73], v11 offset:0
    ds_read_b64_tr_b16 v[74:75], v11 offset:1024
    ds_read_b64_tr_b16 v[76:77], v12 offset:0
    ds_read_b64_tr_b16 v[78:79], v12 offset:1024
    s_add_u32 m0, s26, 98304
    s_nop 0
    buffer_load_dwordx4 v1, s[8:11], s24 offen offset:0 lds
    buffer_load_dwordx4 v1, s[8:11], s24 offen offset:1024 lds
    buffer_load_dwordx4 v1, s[8:11], s24 offen offset:2048 lds
    s_waitcnt lgkmcnt(0)
    v_mfma_f32_16x16x32_bf16 v[32:35], v[64:67], v[96:99], v[32:35]
    ds_read_b128 v[104:107], v6 offset:8192
    ds_read_b128 v[108:111], v6 offset:9216
    v_mfma_f32_16x16x32_bf16 v[36:39], v[64:67], v[100:103], v[36:39]
    ds_read_b64_tr_b16 v[80:81], v9 offset:4096
    buffer_load_dwordx4 v1, s[8:11], s24 offen offset:3072 lds
    v_mfma_f32_16x16x32_bf16 v[40:43], v[68:71], v[96:99], v[40:43]
    ds_read_b64_tr_b16 v[82:83], v9 offset:5120
    s_add_u32 m0, s26, 102400
    s_add_u32 s28, s24, 4096
    v_mfma_f32_16x16x32_bf16 v[44:47], v[68:71], v[100:103], v[44:47]
    ds_read_b64_tr_b16 v[84:85], v10 offset:4096
    buffer_load_dwordx4 v1, s[8:11], s28 offen offset:0 lds
    v_mfma_f32_16x16x32_bf16 v[48:51], v[72:75], v[96:99], v[48:51]
    ds_read_b64_tr_b16 v[86:87], v10 offset:5120
    ds_read_b64_tr_b16 v[88:89], v11 offset:4096
    v_mfma_f32_16x16x32_bf16 v[52:55], v[72:75], v[100:103], v[52:55]
    ds_read_b64_tr_b16 v[90:91], v11 offset:5120
    buffer_load_dwordx4 v1, s[8:11], s28 offen offset:1024 lds
    v_mfma_f32_16x16x32_bf16 v[56:59], v[76:79], v[96:99], v[56:59]
    ds_read_b64_tr_b16 v[92:93], v12 offset:4096
    v_mfma_f32_16x16x32_bf16 v[60:63], v[76:79], v[100:103], v[60:63]
    ds_read_b64_tr_b16 v[94:95], v12 offset:5120
    buffer_load_dwordx4 v1, s[8:11], s28 offen offset:2048 lds
    s_waitcnt lgkmcnt(0)
    v_mfma_f32_16x16x32_bf16 v[32:35], v[80:83], v[104:107], v[32:35]
    ds_read_b128 v[96:99], v6 offset:16384
    ds_read_b128 v[100:103], v6 offset:17408
    v_mfma_f32_16x16x32_bf16 v[36:39], v[80:83], v[108:111], v[36:39]
    ds_read_b64_tr_b16 v[64:65], v9 offset:8192
    buffer_load_dwordx4 v1, s[8:11], s28 offen offset:3072 lds
    s_add_u32 s24, s24, 524288
    v_mfma_f32_16x16x32_bf16 v[40:43], v[84:87], v[104:107], v[40:43]
    ds_read_b64_tr_b16 v[66:67], v9 offset:9216
    s_add_u32 m0, s27, 98304
    v_mfma_f32_16x16x32_bf16 v[44:47], v[84:87], v[108:111], v[44:47]
    ds_read_b64_tr_b16 v[68:69], v10 offset:8192
    buffer_load_dwordx4 v2, s[4:7], s25 offen offset:0 lds
    v_mfma_f32_16x16x32_bf16 v[48:51], v[88:91], v[104:107], v[48:51]
    ds_read_b64_tr_b16 v[70:71], v10 offset:9216
    ds_read_b64_tr_b16 v[72:73], v11 offset:8192
    v_mfma_f32_16x16x32_bf16 v[52:55], v[88:91], v[108:111], v[52:55]
    ds_read_b64_tr_b16 v[74:75], v11 offset:9216
    buffer_load_dwordx4 v3, s[4:7], s25 offen offset:1024 lds
    v_mfma_f32_16x16x32_bf16 v[56:59], v[92:95], v[104:107], v[56:59]
    ds_read_b64_tr_b16 v[76:77], v12 offset:8192
    v_mfma_f32_16x16x32_bf16 v[60:63], v[92:95], v[108:111], v[60:63]
    ds_read_b64_tr_b16 v[78:79], v12 offset:9216
    buffer_load_dwordx4 v4, s[4:7], s25 offen offset:2048 lds
    s_waitcnt lgkmcnt(0)
    v_mfma_f32_16x16x32_bf16 v[32:35], v[64:67], v[96:99], v[32:35]
    ds_read_b128 v[104:107], v6 offset:24576
    ds_read_b128 v[108:111], v6 offset:25600
    v_mfma_f32_16x16x32_bf16 v[36:39], v[64:67], v[100:103], v[36:39]
    ds_read_b64_tr_b16 v[80:81], v9 offset:12288
    buffer_load_dwordx4 v5, s[4:7], s25 offen offset:3072 lds
    s_add_u32 s25, s25, 262144
    v_mfma_f32_16x16x32_bf16 v[40:43], v[68:71], v[96:99], v[40:43]
    ds_read_b64_tr_b16 v[82:83], v9 offset:13312
    v_mfma_f32_16x16x32_bf16 v[44:47], v[68:71], v[100:103], v[44:47]
    ds_read_b64_tr_b16 v[84:85], v10 offset:12288
    v_mfma_f32_16x16x32_bf16 v[48:51], v[72:75], v[96:99], v[48:51]
    ds_read_b64_tr_b16 v[86:87], v10 offset:13312
    ds_read_b64_tr_b16 v[88:89], v11 offset:12288
    v_mfma_f32_16x16x32_bf16 v[52:55], v[72:75], v[100:103], v[52:55]
    ds_read_b64_tr_b16 v[90:91], v11 offset:13312
    v_mfma_f32_16x16x32_bf16 v[56:59], v[76:79], v[96:99], v[56:59]
    ds_read_b64_tr_b16 v[92:93], v12 offset:12288
    v_mfma_f32_16x16x32_bf16 v[60:63], v[76:79], v[100:103], v[60:63]
    ds_read_b64_tr_b16 v[94:95], v12 offset:13312
    s_waitcnt vmcnt(12) lgkmcnt(0)
    s_barrier
    v_mfma_f32_16x16x32_bf16 v[32:35], v[80:83], v[104:107], v[32:35]
    ds_read_b128 v[96:99], v7 offset:0
    ds_read_b128 v[100:103], v7 offset:1024
    v_mfma_f32_16x16x32_bf16 v[36:39], v[80:83], v[108:111], v[36:39]
    ds_read_b64_tr_b16 v[64:65], v13 offset:0
    v_mfma_f32_16x16x32_bf16 v[40:43], v[84:87], v[104:107], v[40:43]
    ds_read_b64_tr_b16 v[66:67], v13 offset:1024
    s_add_u32 m0, s26, 0
    v_mfma_f32_16x16x32_bf16 v[44:47], v[84:87], v[108:111], v[44:47]
    ds_read_b64_tr_b16 v[68:69], v14 offset:0
    buffer_load_dwordx4 v1, s[8:11], s24 offen offset:0 lds
    v_mfma_f32_16x16x32_bf16 v[48:51], v[88:91], v[104:107], v[48:51]
    ds_read_b64_tr_b16 v[70:71], v14 offset:1024
    ds_read_b64_tr_b16 v[72:73], v15 offset:0
    v_mfma_f32_16x16x32_bf16 v[52:55], v[88:91], v[108:111], v[52:55]
    ds_read_b64_tr_b16 v[74:75], v15 offset:1024
    buffer_load_dwordx4 v1, s[8:11], s24 offen offset:1024 lds
    v_mfma_f32_16x16x32_bf16 v[56:59], v[92:95], v[104:107], v[56:59]
    ds_read_b64_tr_b16 v[76:77], v16 offset:0
    v_mfma_f32_16x16x32_bf16 v[60:63], v[92:95], v[108:111], v[60:63]
    ds_read_b64_tr_b16 v[78:79], v16 offset:1024
    buffer_load_dwordx4 v1, s[8:11], s24 offen offset:2048 lds
    s_waitcnt lgkmcnt(0)
    v_mfma_f32_16x16x32_bf16 v[32:35], v[64:67], v[96:99], v[32:35]
    ds_read_b128 v[104:107], v7 offset:8192
    ds_read_b128 v[108:111], v7 offset:9216
    v_mfma_f32_16x16x32_bf16 v[36:39], v[64:67], v[100:103], v[36:39]
    ds_read_b64_tr_b16 v[80:81], v13 offset:4096
    buffer_load_dwordx4 v1, s[8:11], s24 offen offset:3072 lds
    v_mfma_f32_16x16x32_bf16 v[40:43], v[68:71], v[96:99], v[40:43]
    ds_read_b64_tr_b16 v[82:83], v13 offset:5120
    s_add_u32 m0, s26, 4096
    s_add_u32 s28, s24, 4096
    v_mfma_f32_16x16x32_bf16 v[44:47], v[68:71], v[100:103], v[44:47]
    ds_read_b64_tr_b16 v[84:85], v14 offset:4096
    buffer_load_dwordx4 v1, s[8:11], s28 offen offset:0 lds
    v_mfma_f32_16x16x32_bf16 v[48:51], v[72:75], v[96:99], v[48:51]
    ds_read_b64_tr_b16 v[86:87], v14 offset:5120
    ds_read_b64_tr_b16 v[88:89], v15 offset:4096
    v_mfma_f32_16x16x32_bf16 v[52:55], v[72:75], v[100:103], v[52:55]
    ds_read_b64_tr_b16 v[90:91], v15 offset:5120
    buffer_load_dwordx4 v1, s[8:11], s28 offen offset:1024 lds
    v_mfma_f32_16x16x32_bf16 v[56:59], v[76:79], v[96:99], v[56:59]
    ds_read_b64_tr_b16 v[92:93], v16 offset:4096
    v_mfma_f32_16x16x32_bf16 v[60:63], v[76:79], v[100:103], v[60:63]
    ds_read_b64_tr_b16 v[94:95], v16 offset:5120
    buffer_load_dwordx4 v1, s[8:11], s28 offen offset:2048 lds
    s_waitcnt lgkmcnt(0)
    v_mfma_f32_16x16x32_bf16 v[32:35], v[80:83], v[104:107], v[32:35]
    ds_read_b128 v[96:99], v7 offset:16384
    ds_read_b128 v[100:103], v7 offset:17408
    v_mfma_f32_16x16x32_bf16 v[36:39], v[80:83], v[108:111], v[36:39]
    ds_read_b64_tr_b16 v[64:65], v13 offset:8192
    buffer_load_dwordx4 v1, s[8:11], s28 offen offset:3072 lds
    s_add_u32 s24, s24, 524288
    v_mfma_f32_16x16x32_bf16 v[40:43], v[84:87], v[104:107], v[40:43]
    ds_read_b64_tr_b16 v[66:67], v13 offset:9216
    s_add_u32 m0, s27, 0
    v_mfma_f32_16x16x32_bf16 v[44:47], v[84:87], v[108:111], v[44:47]
    ds_read_b64_tr_b16 v[68:69], v14 offset:8192
    buffer_load_dwordx4 v2, s[4:7], s25 offen offset:0 lds
    v_mfma_f32_16x16x32_bf16 v[48:51], v[88:91], v[104:107], v[48:51]
    ds_read_b64_tr_b16 v[70:71], v14 offset:9216
    ds_read_b64_tr_b16 v[72:73], v15 offset:8192
    v_mfma_f32_16x16x32_bf16 v[52:55], v[88:91], v[108:111], v[52:55]
    ds_read_b64_tr_b16 v[74:75], v15 offset:9216
    buffer_load_dwordx4 v3, s[4:7], s25 offen offset:1024 lds
    v_mfma_f32_16x16x32_bf16 v[56:59], v[92:95], v[104:107], v[56:59]
    ds_read_b64_tr_b16 v[76:77], v16 offset:8192
    v_mfma_f32_16x16x32_bf16 v[60:63], v[92:95], v[108:111], v[60:63]
    ds_read_b64_tr_b16 v[78:79], v16 offset:9216
    buffer_load_dwordx4 v4, s[4:7], s25 offen offset:2048 lds
    s_waitcnt lgkmcnt(0)
    v_mfma_f32_16x16x32_bf16 v[32:35], v[64:67], v[96:99], v[32:35]
    ds_read_b128 v[104:107], v7 offset:24576
    ds_read_b128 v[108:111], v7 offset:25600
    v_mfma_f32_16x16x32_bf16 v[36:39], v[64:67], v[100:103], v[36:39]
    ds_read_b64_tr_b16 v[80:81], v13 offset:12288
    buffer_load_dwordx4 v5, s[4:7], s25 offen offset:3072 lds
    s_add_u32 s25, s25, 262144
    v_mfma_f32_16x16x32_bf16 v[40:43], v[68:71], v[96:99], v[40:43]
    ds_read_b64_tr_b16 v[82:83], v13 offset:13312
    v_mfma_f32_16x16x32_bf16 v[44:47], v[68:71], v[100:103], v[44:47]
    ds_read_b64_tr_b16 v[84:85], v14 offset:12288
    v_mfma_f32_16x16x32_bf16 v[48:51], v[72:75], v[96:99], v[48:51]
    ds_read_b64_tr_b16 v[86:87], v14 offset:13312
    ds_read_b64_tr_b16 v[88:89], v15 offset:12288
    v_mfma_f32_16x16x32_bf16 v[52:55], v[72:75], v[100:103], v[52:55]
    ds_read_b64_tr_b16 v[90:91], v15 offset:13312
    v_mfma_f32_16x16x32_bf16 v[56:59], v[76:79], v[96:99], v[56:59]
    ds_read_b64_tr_b16 v[92:93], v16 offset:12288
    v_mfma_f32_16x16x32_bf16 v[60:63], v[76:79], v[100:103], v[60:63]
    ds_read_b64_tr_b16 v[94:95], v16 offset:13312
    s_waitcnt vmcnt(12) lgkmcnt(0)
    s_barrier
    v_mfma_f32_16x16x32_bf16 v[32:35], v[80:83], v[104:107], v[32:35]
    ds_read_b128 v[96:99], v8 offset:0
    ds_read_b128 v[100:103], v8 offset:1024
    v_mfma_f32_16x16x32_bf16 v[36:39], v[80:83], v[108:111], v[36:39]
    ds_read_b64_tr_b16 v[64:65], v17 offset:0
    v_mfma_f32_16x16x32_bf16 v[40:43], v[84:87], v[104:107], v[40:43]
    ds_read_b64_tr_b16 v[66:67], v17 offset:1024
    s_add_u32 m0, s26, 49152
    v_mfma_f32_16x16x32_bf16 v[44:47], v[84:87], v[108:111], v[44:47]
    ds_read_b64_tr_b16 v[68:69], v18 offset:0
    buffer_load_dwordx4 v1, s[8:11], s24 offen offset:0 lds
    v_mfma_f32_16x16x32_bf16 v[48:51], v[88:91], v[104:107], v[48:51]
    ds_read_b64_tr_b16 v[70:71], v18 offset:1024
    ds_read_b64_tr_b16 v[72:73], v19 offset:0
    v_mfma_f32_16x16x32_bf16 v[52:55], v[88:91], v[108:111], v[52:55]
    ds_read_b64_tr_b16 v[74:75], v19 offset:1024
    buffer_load_dwordx4 v1, s[8:11], s24 offen offset:1024 lds
    v_mfma_f32_16x16x32_bf16 v[56:59], v[92:95], v[104:107], v[56:59]
    ds_read_b64_tr_b16 v[76:77], v20 offset:0
    v_mfma_f32_16x16x32_bf16 v[60:63], v[92:95], v[108:111], v[60:63]
    ds_read_b64_tr_b16 v[78:79], v20 offset:1024
    buffer_load_dwordx4 v1, s[8:11], s24 offen offset:2048 lds
    s_waitcnt lgkmcnt(0)
    v_mfma_f32_16x16x32_bf16 v[32:35], v[64:67], v[96:99], v[32:35]
    ds_read_b128 v[104:107], v8 offset:8192
    ds_read_b128 v[108:111], v8 offset:9216
    v_mfma_f32_16x16x32_bf16 v[36:39], v[64:67], v[100:103], v[36:39]
    ds_read_b64_tr_b16 v[80:81], v17 offset:4096
    buffer_load_dwordx4 v1, s[8:11], s24 offen offset:3072 lds
    v_mfma_f32_16x16x32_bf16 v[40:43], v[68:71], v[96:99], v[40:43]
    ds_read_b64_tr_b16 v[82:83], v17 offset:5120
    s_add_u32 m0, s26, 53248
    s_add_u32 s28, s24, 4096
    v_mfma_f32_16x16x32_bf16 v[44:47], v[68:71], v[100:103], v[44:47]
    ds_read_b64_tr_b16 v[84:85], v18 offset:4096
    buffer_load_dwordx4 v1, s[8:11], s28 offen offset:0 lds
    v_mfma_f32_16x16x32_bf16 v[48:51], v[72:75], v[96:99], v[48:51]
    ds_read_b64_tr_b16 v[86:87], v18 offset:5120
    ds_read_b64_tr_b16 v[88:89], v19 offset:4096
    v_mfma_f32_16x16x32_bf16 v[52:55], v[72:75], v[100:103], v[52:55]
    ds_read_b64_tr_b16 v[90:91], v19 offset:5120
    buffer_load_dwordx4 v1, s[8:11], s28 offen offset:1024 lds
    v_mfma_f32_16x16x32_bf16 v[56:59], v[76:79], v[96:99], v[56:59]
    ds_read_b64_tr_b16 v[92:93], v20 offset:4096
    v_mfma_f32_16x16x32_bf16 v[60:63], v[76:79], v[100:103], v[60:63]
    ds_read_b64_tr_b16 v[94:95], v20 offset:5120
    buffer_load_dwordx4 v1, s[8:11], s28 offen offset:2048 lds
    s_waitcnt lgkmcnt(0)
    v_mfma_f32_16x16x32_bf16 v[32:35], v[80:83], v[104:107], v[32:35]
    ds_read_b128 v[96:99], v8 offset:16384
    ds_read_b128 v[100:103], v8 offset:17408
    v_mfma_f32_16x16x32_bf16 v[36:39], v[80:83], v[108:111], v[36:39]
    ds_read_b64_tr_b16 v[64:65], v17 offset:8192
    buffer_load_dwordx4 v1, s[8:11], s28 offen offset:3072 lds
    s_add_u32 s24, s24, 524288
    v_mfma_f32_16x16x32_bf16 v[40:43], v[84:87], v[104:107], v[40:43]
    ds_read_b64_tr_b16 v[66:67], v17 offset:9216
    s_add_u32 m0, s27, 49152
    v_mfma_f32_16x16x32_bf16 v[44:47], v[84:87], v[108:111], v[44:47]
    ds_read_b64_tr_b16 v[68:69], v18 offset:8192
    buffer_load_dwordx4 v2, s[4:7], s25 offen offset:0 lds
    v_mfma_f32_16x16x32_bf16 v[48:51], v[88:91], v[104:107], v[48:51]
    ds_read_b64_tr_b16 v[70:71], v18 offset:9216
    ds_read_b64_tr_b16 v[72:73], v19 offset:8192
    v_mfma_f32_16x16x32_bf16 v[52:55], v[88:91], v[108:111], v[52:55]
    ds_read_b64_tr_b16 v[74:75], v19 offset:9216
    buffer_load_dwordx4 v3, s[4:7], s25 offen offset:1024 lds
    v_mfma_f32_16x16x32_bf16 v[56:59], v[92:95], v[104:107], v[56:59]
    ds_read_b64_tr_b16 v[76:77], v20 offset:8192
    v_mfma_f32_16x16x32_bf16 v[60:63], v[92:95], v[108:111], v[60:63]
    ds_read_b64_tr_b16 v[78:79], v20 offset:9216
    buffer_load_dwordx4 v4, s[4:7], s25 offen offset:2048 lds
    s_waitcnt lgkmcnt(0)
    v_mfma_f32_16x16x32_bf16 v[32:35], v[64:67], v[96:99], v[32:35]
    ds_read_b128 v[104:107], v8 offset:24576
    ds_read_b128 v[108:111], v8 offset:25600
    v_mfma_f32_16x16x32_bf16 v[36:39], v[64:67], v[100:103], v[36:39]
    ds_read_b64_tr_b16 v[80:81], v17 offset:12288
    buffer_load_dwordx4 v5, s[4:7], s25 offen offset:3072 lds
    s_add_u32 s25, s25, 262144
    v_mfma_f32_16x16x32_bf16 v[40:43], v[68:71], v[96:99], v[40:43]
    ds_read_b64_tr_b16 v[82:83], v17 offset:13312
    v_mfma_f32_16x16x32_bf16 v[44:47], v[68:71], v[100:103], v[44:47]
    ds_read_b64_tr_b16 v[84:85], v18 offset:12288
    v_mfma_f32_16x16x32_bf16 v[48:51], v[72:75], v[96:99], v[48:51]
    ds_read_b64_tr_b16 v[86:87], v18 offset:13312
    ds_read_b64_tr_b16 v[88:89], v19 offset:12288
    v_mfma_f32_16x16x32_bf16 v[52:55], v[72:75], v[100:103], v[52:55]
    ds_read_b64_tr_b16 v[90:91], v19 offset:13312
    v_mfma_f32_16x16x32_bf16 v[56:59], v[76:79], v[96:99], v[56:59]
    ds_read_b64_tr_b16 v[92:93], v20 offset:12288
    v_mfma_f32_16x16x32_bf16 v[60:63], v[76:79], v[100:103], v[60:63]
    ds_read_b64_tr_b16 v[94:95], v20 offset:13312
    s_waitcnt vmcnt(12) lgkmcnt(0)
    s_barrier
    v_mfma_f32_16x16x32_bf16 v[32:35], v[80:83], v[104:107], v[32:35]
    ds_read_b128 v[96:99], v6 offset:0
    ds_read_b128 v[100:103], v6 offset:1024
    v_mfma_f32_16x16x32_bf16 v[36:39], v[80:83], v[108:111], v[36:39]
    ds_read_b64_tr_b16 v[64:65], v9 offset:0
    v_mfma_f32_16x16x32_bf16 v[40:43], v[84:87], v[104:107], v[40:43]
    ds_read_b64_tr_b16 v[66:67], v9 offset:1024
    s_add_u32 m0, s26, 98304
    v_mfma_f32_16x16x32_bf16 v[44:47], v[84:87], v[108:111], v[44:47]
    ds_read_b64_tr_b16 v[68:69], v10 offset:0
    buffer_load_dwordx4 v1, s[8:11], s24 offen offset:0 lds
    v_mfma_f32_16x16x32_bf16 v[48:51], v[88:91], v[104:107], v[48:51]
    ds_read_b64_tr_b16 v[70:71], v10 offset:1024
    ds_read_b64_tr_b16 v[72:73], v11 offset:0
    v_mfma_f32_16x16x32_bf16 v[52:55], v[88:91], v[108:111], v[52:55]
    ds_read_b64_tr_b16 v[74:75], v11 offset:1024
    buffer_load_dwordx4 v1, s[8:11], s24 offen offset:1024 lds
    v_mfma_f32_16x16x32_bf16 v[56:59], v[92:95], v[104:107], v[56:59]
    ds_read_b64_tr_b16 v[76:77], v12 offset:0
    v_mfma_f32_16x16x32_bf16 v[60:63], v[92:95], v[108:111], v[60:63]
    ds_read_b64_tr_b16 v[78:79], v12 offset:1024
    buffer_load_dwordx4 v1, s[8:11], s24 offen offset:2048 lds
    s_waitcnt lgkmcnt(0)
    v_mfma_f32_16x16x32_bf16 v[32:35], v[64:67], v[96:99], v[32:35]
    ds_read_b128 v[104:107], v6 offset:8192
    ds_read_b128 v[108:111], v6 offset:9216
    v_mfma_f32_16x16x32_bf16 v[36:39], v[64:67], v[100:103], v[36:39]
    ds_read_b64_tr_b16 v[80:81], v9 offset:4096
    buffer_load_dwordx4 v1, s[8:11], s24 offen offset:3072 lds
    v_mfma_f32_16x16x32_bf16 v[40:43], v[68:71], v[96:99], v[40:43]
    ds_read_b64_tr_b16 v[82:83], v9 offset:5120
    s_add_u32 m0, s26, 102400
    s_add_u32 s28, s24, 4096
    v_mfma_f32_16x16x32_bf16 v[44:47], v[68:71], v[100:103], v[44:47]
    ds_read_b64_tr_b16 v[84:85], v10 offset:4096
    buffer_load_dwordx4 v1, s[8:11], s28 offen offset:0 lds
    v_mfma_f32_16x16x32_bf16 v[48:51], v[72:75], v[96:99], v[48:51]
    ds_read_b64_tr_b16 v[86:87], v10 offset:5120
    ds_read_b64_tr_b16 v[88:89], v11 offset:4096
    v_mfma_f32_16x16x32_bf16 v[52:55], v[72:75], v[100:103], v[52:55]
    ds_read_b64_tr_b16 v[90:91], v11 offset:5120
    buffer_load_dwordx4 v1, s[8:11], s28 offen offset:1024 lds
    v_mfma_f32_16x16x32_bf16 v[56:59], v[76:79], v[96:99], v[56:59]
    ds_read_b64_tr_b16 v[92:93], v12 offset:4096
    v_mfma_f32_16x16x32_bf16 v[60:63], v[76:79], v[100:103], v[60:63]
    ds_read_b64_tr_b16 v[94:95], v12 offset:5120
    buffer_load_dwordx4 v1, s[8:11], s28 offen offset:2048 lds
    s_waitcnt lgkmcnt(0)
    v_mfma_f32_16x16x32_bf16 v[32:35], v[80:83], v[104:107], v[32:35]
    ds_read_b128 v[96:99], v6 offset:16384
    ds_read_b128 v[100:103], v6 offset:17408
    v_mfma_f32_16x16x32_bf16 v[36:39], v[80:83], v[108:111], v[36:39]
    ds_read_b64_tr_b16 v[64:65], v9 offset:8192
    buffer_load_dwordx4 v1, s[8:11], s28 offen offset:3072 lds
    s_add_u32 s24, s24, 524288
    v_mfma_f32_16x16x32_bf16 v[40:43], v[84:87], v[104:107], v[40:43]
    ds_read_b64_tr_b16 v[66:67], v9 offset:9216
    s_add_u32 m0, s27, 98304
    v_mfma_f32_16x16x32_bf16 v[44:47], v[84:87], v[108:111], v[44:47]
    ds_read_b64_tr_b16 v[68:69], v10 offset:8192
    buffer_load_dwordx4 v2, s[4:7], s25 offen offset:0 lds
    v_mfma_f32_16x16x32_bf16 v[48:51], v[88:91], v[104:107], v[48:51]
    ds_read_b64_tr_b16 v[70:71], v10 offset:9216
    ds_read_b64_tr_b16 v[72:73], v11 offset:8192
    v_mfma_f32_16x16x32_bf16 v[52:55], v[88:91], v[108:111], v[52:55]
    ds_read_b64_tr_b16 v[74:75], v11 offset:9216
    buffer_load_dwordx4 v3, s[4:7], s25 offen offset:1024 lds
    v_mfma_f32_16x16x32_bf16 v[56:59], v[92:95], v[104:107], v[56:59]
    ds_read_b64_tr_b16 v[76:77], v12 offset:8192
    v_mfma_f32_16x16x32_bf16 v[60:63], v[92:95], v[108:111], v[60:63]
    ds_read_b64_tr_b16 v[78:79], v12 offset:9216
    buffer_load_dwordx4 v4, s[4:7], s25 offen offset:2048 lds
    s_waitcnt lgkmcnt(0)
    v_mfma_f32_16x16x32_bf16 v[32:35], v[64:67], v[96:99], v[32:35]
    ds_read_b128 v[104:107], v6 offset:24576
    ds_read_b128 v[108:111], v6 offset:25600
    v_mfma_f32_16x16x32_bf16 v[36:39], v[64:67], v[100:103], v[36:39]
    ds_read_b64_tr_b16 v[80:81], v9 offset:12288
    buffer_load_dwordx4 v5, s[4:7], s25 offen offset:3072 lds
    s_add_u32 s25, s25, 262144
    v_mfma_f32_16x16x32_bf16 v[40:43], v[68:71], v[96:99], v[40:43]
    ds_read_b64_tr_b16 v[82:83], v9 offset:13312
    v_mfma_f32_16x16x32_bf16 v[44:47], v[68:71], v[100:103], v[44:47]
    ds_read_b64_tr_b16 v[84:85], v10 offset:12288
    v_mfma_f32_16x16x32_bf16 v[48:51], v[72:75], v[96:99], v[48:51]
    ds_read_b64_tr_b16 v[86:87], v10 offset:13312
    ds_read_b64_tr_b16 v[88:89], v11 offset:12288
    v_mfma_f32_16x16x32_bf16 v[52:55], v[72:75], v[100:103], v[52:55]
    ds_read_b64_tr_b16 v[90:91], v11 offset:13312
    v_mfma_f32_16x16x32_bf16 v[56:59], v[76:79], v[96:99], v[56:59]
    ds_read_b64_tr_b16 v[92:93], v12 offset:12288
    v_mfma_f32_16x16x32_bf16 v[60:63], v[76:79], v[100:103], v[60:63]
    ds_read_b64_tr_b16 v[94:95], v12 offset:13312
    s_waitcnt vmcnt(12) lgkmcnt(0)
    s_barrier
    v_mfma_f32_16x16x32_bf16 v[32:35], v[80:83], v[104:107], v[32:35]
    ds_read_b128 v[96:99], v7 offset:0
    ds_read_b128 v[100:103], v7 offset:1024
    v_mfma_f32_16x16x32_bf16 v[36:39], v[80:83], v[108:111], v[36:39]
    ds_read_b64_tr_b16 v[64:65], v13 offset:0
    v_mfma_f32_16x16x32_bf16 v[40:43], v[84:87], v[104:107], v[40:43]
    ds_read_b64_tr_b16 v[66:67], v13 offset:1024
    s_add_u32 m0, s26, 0
    v_mfma_f32_16x16x32_bf16 v[44:47], v[84:87], v[108:111], v[44:47]
    ds_read_b64_tr_b16 v[68:69], v14 offset:0
    buffer_load_dwordx4 v1, s[8:11], s24 offen offset:0 lds
    v_mfma_f32_16x16x32_bf16 v[48:51], v[88:91], v[104:107], v[48:51]
    ds_read_b64_tr_b16 v[70:71], v14 offset:1024
    ds_read_b64_tr_b16 v[72:73], v15 offset:0
    v_mfma_f32_16x16x32_bf16 v[52:55], v[88:91], v[108:111], v[52:55]
    ds_read_b64_tr_b16 v[74:75], v15 offset:1024
    buffer_load_dwordx4 v1, s[8:11], s24 offen offset:1024 lds
    v_mfma_f32_16x16x32_bf16 v[56:59], v[92:95], v[104:107], v[56:59]
    ds_read_b64_tr_b16 v[76:77], v16 offset:0
    v_mfma_f32_16x16x32_bf16 v[60:63], v[92:95], v[108:111], v[60:63]
    ds_read_b64_tr_b16 v[78:79], v16 offset:1024
    buffer_load_dwordx4 v1, s[8:11], s24 offen offset:2048 lds
    s_waitcnt lgkmcnt(0)
    v_mfma_f32_16x16x32_bf16 v[32:35], v[64:67], v[96:99], v[32:35]
    ds_read_b128 v[104:107], v7 offset:8192
    ds_read_b128 v[108:111], v7 offset:9216
    v_mfma_f32_16x16x32_bf16 v[36:39], v[64:67], v[100:103], v[36:39]
    ds_read_b64_tr_b16 v[80:81], v13 offset:4096
    buffer_load_dwordx4 v1, s[8:11], s24 offen offset:3072 lds
    v_mfma_f32_16x16x32_bf16 v[40:43], v[68:71], v[96:99], v[40:43]
    ds_read_b64_tr_b16 v[82:83], v13 offset:5120
    s_add_u32 m0, s26, 4096
    s_add_u32 s28, s24, 4096
    v_mfma_f32_16x16x32_bf16 v[44:47], v[68:71], v[100:103], v[44:47]
    ds_read_b64_tr_b16 v[84:85], v14 offset:4096
    buffer_load_dwordx4 v1, s[8:11], s28 offen offset:0 lds
    v_mfma_f32_16x16x32_bf16 v[48:51], v[72:75], v[96:99], v[48:51]
    ds_read_b64_tr_b16 v[86:87], v14 offset:5120
    ds_read_b64_tr_b16 v[88:89], v15 offset:4096
    v_mfma_f32_16x16x32_bf16 v[52:55], v[72:75], v[100:103], v[52:55]
    ds_read_b64_tr_b16 v[90:91], v15 offset:5120
    buffer_load_dwordx4 v1, s[8:11], s28 offen offset:1024 lds
    v_mfma_f32_16x16x32_bf16 v[56:59], v[76:79], v[96:99], v[56:59]
    ds_read_b64_tr_b16 v[92:93], v16 offset:4096
    v_mfma_f32_16x16x32_bf16 v[60:63], v[76:79], v[100:103], v[60:63]
    ds_read_b64_tr_b16 v[94:95], v16 offset:5120
    buffer_load_dwordx4 v1, s[8:11], s28 offen offset:2048 lds
    s_waitcnt lgkmcnt(0)
    v_mfma_f32_16x16x32_bf16 v[32:35], v[80:83], v[104:107], v[32:35]
    ds_read_b128 v[96:99], v7 offset:16384
    ds_read_b128 v[100:103], v7 offset:17408
    v_mfma_f32_16x16x32_bf16 v[36:39], v[80:83], v[108:111], v[36:39]
    ds_read_b64_tr_b16 v[64:65], v13 offset:8192
    buffer_load_dwordx4 v1, s[8:11], s28 offen offset:3072 lds
    s_add_u32 s24, s24, 524288
    v_mfma_f32_16x16x32_bf16 v[40:43], v[84:87], v[104:107], v[40:43]
    ds_read_b64_tr_b16 v[66:67], v13 offset:9216
    s_add_u32 m0, s27, 0
    v_mfma_f32_16x16x32_bf16 v[44:47], v[84:87], v[108:111], v[44:47]
    ds_read_b64_tr_b16 v[68:69], v14 offset:8192
    buffer_load_dwordx4 v2, s[4:7], s25 offen offset:0 lds
    v_mfma_f32_16x16x32_bf16 v[48:51], v[88:91], v[104:107], v[48:51]
    ds_read_b64_tr_b16 v[70:71], v14 offset:9216
    ds_read_b64_tr_b16 v[72:73], v15 offset:8192
    v_mfma_f32_16x16x32_bf16 v[52:55], v[88:91], v[108:111], v[52:55]
    ds_read_b64_tr_b16 v[74:75], v15 offset:9216
    buffer_load_dwordx4 v3, s[4:7], s25 offen offset:1024 lds
    v_mfma_f32_16x16x32_bf16 v[56:59], v[92:95], v[104:107], v[56:59]
    ds_read_b64_tr_b16 v[76:77], v16 offset:8192
    v_mfma_f32_16x16x32_bf16 v[60:63], v[92:95], v[108:111], v[60:63]
    ds_read_b64_tr_b16 v[78:79], v16 offset:9216
    buffer_load_dwordx4 v4, s[4:7], s25 offen offset:2048 lds
    s_waitcnt lgkmcnt(0)
    v_mfma_f32_16x16x32_bf16 v[32:35], v[64:67], v[96:99], v[32:35]
    ds_read_b128 v[104:107], v7 offset:24576
    ds_read_b128 v[108:111], v7 offset:25600
    v_mfma_f32_16x16x32_bf16 v[36:39], v[64:67], v[100:103], v[36:39]
    ds_read_b64_tr_b16 v[80:81], v13 offset:12288
    buffer_load_dwordx4 v5, s[4:7], s25 offen offset:3072 lds
    s_add_u32 s25, s25, 262144
    v_mfma_f32_16x16x32_bf16 v[40:43], v[68:71], v[96:99], v[40:43]
    ds_read_b64_tr_b16 v[82:83], v13 offset:13312
    v_mfma_f32_16x16x32_bf16 v[44:47], v[68:71], v[100:103], v[44:47]
    ds_read_b64_tr_b16 v[84:85], v14 offset:12288
    v_mfma_f32_16x16x32_bf16 v[48:51], v[72:75], v[96:99], v[48:51]
    ds_read_b64_tr_b16 v[86:87], v14 offset:13312
    ds_read_b64_tr_b16 v[88:89], v15 offset:12288
    v_mfma_f32_16x16x32_bf16 v[52:55], v[72:75], v[100:103], v[52:55]
    ds_read_b64_tr_b16 v[90:91], v15 offset:13312
    v_mfma_f32_16x16x32_bf16 v[56:59], v[76:79], v[96:99], v[56:59]
    ds_read_b64_tr_b16 v[92:93], v16 offset:12288
    v_mfma_f32_16x16x32_bf16 v[60:63], v[76:79], v[100:103], v[60:63]
    ds_read_b64_tr_b16 v[94:95], v16 offset:13312
    s_waitcnt vmcnt(12) lgkmcnt(0)
    s_barrier
    v_mfma_f32_16x16x32_bf16 v[32:35], v[80:83], v[104:107], v[32:35]
    ds_read_b128 v[96:99], v8 offset:0
    ds_read_b128 v[100:103], v8 offset:1024
    v_mfma_f32_16x16x32_bf16 v[36:39], v[80:83], v[108:111], v[36:39]
    ds_read_b64_tr_b16 v[64:65], v17 offset:0
    v_mfma_f32_16x16x32_bf16 v[40:43], v[84:87], v[104:107], v[40:43]
    ds_read_b64_tr_b16 v[66:67], v17 offset:1024
    s_add_u32 m0, s26, 49152
    v_mfma_f32_16x16x32_bf16 v[44:47], v[84:87], v[108:111], v[44:47]
    ds_read_b64_tr_b16 v[68:69], v18 offset:0
    buffer_load_dwordx4 v1, s[8:11], s24 offen offset:0 lds
    v_mfma_f32_16x16x32_bf16 v[48:51], v[88:91], v[104:107], v[48:51]
    ds_read_b64_tr_b16 v[70:71], v18 offset:1024
    ds_read_b64_tr_b16 v[72:73], v19 offset:0
    v_mfma_f32_16x16x32_bf16 v[52:55], v[88:91], v[108:111], v[52:55]
    ds_read_b64_tr_b16 v[74:75], v19 offset:1024
    buffer_load_dwordx4 v1, s[8:11], s24 offen offset:1024 lds
    v_mfma_f32_16x16x32_bf16 v[56:59], v[92:95], v[104:107], v[56:59]
    ds_read_b64_tr_b16 v[76:77], v20 offset:0
    v_mfma_f32_16x16x32_bf16 v[60:63], v[92:95], v[108:111], v[60:63]
    ds_read_b64_tr_b16 v[78:79], v20 offset:1024
    buffer_load_dwordx4 v1, s[8:11], s24 offen offset:2048 lds
    s_waitcnt lgkmcnt(0)
    v_mfma_f32_16x16x32_bf16 v[32:35], v[64:67], v[96:99], v[32:35]
    ds_read_b128 v[104:107], v8 offset:8192
    ds_read_b128 v[108:111], v8 offset:9216
    v_mfma_f32_16x16x32_bf16 v[36:39], v[64:67], v[100:103], v[36:39]
    ds_read_b64_tr_b16 v[80:81], v17 offset:4096
    buffer_load_dwordx4 v1, s[8:11], s24 offen offset:3072 lds
    v_mfma_f32_16x16x32_bf16 v[40:43], v[68:71], v[96:99], v[40:43]
    ds_read_b64_tr_b16 v[82:83], v17 offset:5120
    s_add_u32 m0, s26, 53248
    s_add_u32 s28, s24, 4096
    v_mfma_f32_16x16x32_bf16 v[44:47], v[68:71], v[100:103], v[44:47]
    ds_read_b64_tr_b16 v[84:85], v18 offset:4096
    buffer_load_dwordx4 v1, s[8:11], s28 offen offset:0 lds
    v_mfma_f32_16x16x32_bf16 v[48:51], v[72:75], v[96:99], v[48:51]
    ds_read_b64_tr_b16 v[86:87], v18 offset:5120
    ds_read_b64_tr_b16 v[88:89], v19 offset:4096
    v_mfma_f32_16x16x32_bf16 v[52:55], v[72:75], v[100:103], v[52:55]
    ds_read_b64_tr_b16 v[90:91], v19 offset:5120
    buffer_load_dwordx4 v1, s[8:11], s28 offen offset:1024 lds
    v_mfma_f32_16x16x32_bf16 v[56:59], v[76:79], v[96:99], v[56:59]
    ds_read_b64_tr_b16 v[92:93], v20 offset:4096
    v_mfma_f32_16x16x32_bf16 v[60:63], v[76:79], v[100:103], v[60:63]
    ds_read_b64_tr_b16 v[94:95], v20 offset:5120
    buffer_load_dwordx4 v1, s[8:11], s28 offen offset:2048 lds
    s_waitcnt lgkmcnt(0)
    v_mfma_f32_16x16x32_bf16 v[32:35], v[80:83], v[104:107], v[32:35]
    ds_read_b128 v[96:99], v8 offset:16384
    ds_read_b128 v[100:103], v8 offset:17408
    v_mfma_f32_16x16x32_bf16 v[36:39], v[80:83], v[108:111], v[36:39]
    ds_read_b64_tr_b16 v[64:65], v17 offset:8192
    buffer_load_dwordx4 v1, s[8:11], s28 offen offset:3072 lds
    s_add_u32 s24, s24, 524288
    v_mfma_f32_16x16x32_bf16 v[40:43], v[84:87], v[104:107], v[40:43]
    ds_read_b64_tr_b16 v[66:67], v17 offset:9216
    s_add_u32 m0, s27, 49152
    v_mfma_f32_16x16x32_bf16 v[44:47], v[84:87], v[108:111], v[44:47]
    ds_read_b64_tr_b16 v[68:69], v18 offset:8192
    buffer_load_dwordx4 v2, s[4:7], s25 offen offset:0 lds
    v_mfma_f32_16x16x32_bf16 v[48:51], v[88:91], v[104:107], v[48:51]
    ds_read_b64_tr_b16 v[70:71], v18 offset:9216
    ds_read_b64_tr_b16 v[72:73], v19 offset:8192
    v_mfma_f32_16x16x32_bf16 v[52:55], v[88:91], v[108:111], v[52:55]
    ds_read_b64_tr_b16 v[74:75], v19 offset:9216
    buffer_load_dwordx4 v3, s[4:7], s25 offen offset:1024 lds
    v_mfma_f32_16x16x32_bf16 v[56:59], v[92:95], v[104:107], v[56:59]
    ds_read_b64_tr_b16 v[76:77], v20 offset:8192
    v_mfma_f32_16x16x32_bf16 v[60:63], v[92:95], v[108:111], v[60:63]
    ds_read_b64_tr_b16 v[78:79], v20 offset:9216
    buffer_load_dwordx4 v4, s[4:7], s25 offen offset:2048 lds
    s_waitcnt lgkmcnt(0)
    v_mfma_f32_16x16x32_bf16 v[32:35], v[64:67], v[96:99], v[32:35]
    ds_read_b128 v[104:107], v8 offset:24576
    ds_read_b128 v[108:111], v8 offset:25600
    v_mfma_f32_16x16x32_bf16 v[36:39], v[64:67], v[100:103], v[36:39]
    ds_read_b64_tr_b16 v[80:81], v17 offset:12288
    buffer_load_dwordx4 v5, s[4:7], s25 offen offset:3072 lds
    s_add_u32 s25, s25, 262144
    v_mfma_f32_16x16x32_bf16 v[40:43], v[68:71], v[96:99], v[40:43]
    ds_read_b64_tr_b16 v[82:83], v17 offset:13312
    v_mfma_f32_16x16x32_bf16 v[44:47], v[68:71], v[100:103], v[44:47]
    ds_read_b64_tr_b16 v[84:85], v18 offset:12288
    v_mfma_f32_16x16x32_bf16 v[48:51], v[72:75], v[96:99], v[48:51]
    ds_read_b64_tr_b16 v[86:87], v18 offset:13312
    ds_read_b64_tr_b16 v[88:89], v19 offset:12288
    v_mfma_f32_16x16x32_bf16 v[52:55], v[72:75], v[100:103], v[52:55]
    ds_read_b64_tr_b16 v[90:91], v19 offset:13312
    v_mfma_f32_16x16x32_bf16 v[56:59], v[76:79], v[96:99], v[56:59]
    ds_read_b64_tr_b16 v[92:93], v20 offset:12288
    v_mfma_f32_16x16x32_bf16 v[60:63], v[76:79], v[100:103], v[60:63]
    ds_read_b64_tr_b16 v[94:95], v20 offset:13312
    s_waitcnt vmcnt(12) lgkmcnt(0)
    s_barrier
    v_mfma_f32_16x16x32_bf16 v[32:35], v[80:83], v[104:107], v[32:35]
    ds_read_b128 v[96:99], v6 offset:0
    ds_read_b128 v[100:103], v6 offset:1024
    v_mfma_f32_16x16x32_bf16 v[36:39], v[80:83], v[108:111], v[36:39]
    ds_read_b64_tr_b16 v[64:65], v9 offset:0
    v_mfma_f32_16x16x32_bf16 v[40:43], v[84:87], v[104:107], v[40:43]
    ds_read_b64_tr_b16 v[66:67], v9 offset:1024
    v_mfma_f32_16x16x32_bf16 v[44:47], v[84:87], v[108:111], v[44:47]
    ds_read_b64_tr_b16 v[68:69], v10 offset:0
    v_mfma_f32_16x16x32_bf16 v[48:51], v[88:91], v[104:107], v[48:51]
    ds_read_b64_tr_b16 v[70:71], v10 offset:1024
    ds_read_b64_tr_b16 v[72:73], v11 offset:0
    v_mfma_f32_16x16x32_bf16 v[52:55], v[88:91], v[108:111], v[52:55]
    ds_read_b64_tr_b16 v[74:75], v11 offset:1024
    v_mfma_f32_16x16x32_bf16 v[56:59], v[92:95], v[104:107], v[56:59]
    ds_read_b64_tr_b16 v[76:77], v12 offset:0
    v_mfma_f32_16x16x32_bf16 v[60:63], v[92:95], v[108:111], v[60:63]
    ds_read_b64_tr_b16 v[78:79], v12 offset:1024
    s_waitcnt lgkmcnt(0)
    v_mfma_f32_16x16x32_bf16 v[32:35], v[64:67], v[96:99], v[32:35]
    ds_read_b128 v[104:107], v6 offset:8192
    ds_read_b128 v[108:111], v6 offset:9216
    v_mfma_f32_16x16x32_bf16 v[36:39], v[64:67], v[100:103], v[36:39]
    ds_read_b64_tr_b16 v[80:81], v9 offset:4096
    buffer_load_dwordx2 v[112:113], v28, s[12:15], s34 offen offset:0
    buffer_load_dwordx2 v[114:115], v28, s[12:15], s34 offen offset:32
    v_mfma_f32_16x16x32_bf16 v[40:43], v[68:71], v[96:99], v[40:43]
    ds_read_b64_tr_b16 v[82:83], v9 offset:5120
    buffer_load_dwordx2 v[116:117], v28, s[12:15], s34 offen offset:64
    buffer_load_dwordx2 v[118:119], v28, s[12:15], s34 offen offset:96
    v_mfma_f32_16x16x32_bf16 v[44:47], v[68:71], v[100:103], v[44:47]
    ds_read_b64_tr_b16 v[84:85], v10 offset:4096
    buffer_load_dwordx2 v[120:121], v28, s[12:15], s37 offen offset:0
    buffer_load_dwordx2 v[122:123], v28, s[12:15], s37 offen offset:32
    v_mfma_f32_16x16x32_bf16 v[48:51], v[72:75], v[96:99], v[48:51]
    ds_read_b64_tr_b16 v[86:87], v10 offset:5120
    ds_read_b64_tr_b16 v[88:89], v11 offset:4096
    buffer_load_dwordx2 v[124:125], v28, s[12:15], s37 offen offset:64
    buffer_load_dwordx2 v[126:127], v28, s[12:15], s37 offen offset:96
    v_mfma_f32_16x16x32_bf16 v[52:55], v[72:75], v[100:103], v[52:55]
    ds_read_b64_tr_b16 v[90:91], v11 offset:5120
    buffer_load_dword v22, v21, s[8:11], s38 offen
    v_mfma_f32_16x16x32_bf16 v[56:59], v[76:79], v[96:99], v[56:59]
    ds_read_b64_tr_b16 v[92:93], v12 offset:4096
    v_mfma_f32_16x16x32_bf16 v[60:63], v[76:79], v[100:103], v[60:63]
    ds_read_b64_tr_b16 v[94:95], v12 offset:5120
    s_waitcnt lgkmcnt(0)
    v_mfma_f32_16x16x32_bf16 v[32:35], v[80:83], v[104:107], v[32:35]
    ds_read_b128 v[96:99], v6 offset:16384
    ds_read_b128 v[100:103], v6 offset:17408
    v_mfma_f32_16x16x32_bf16 v[36:39], v[80:83], v[108:111], v[36:39]
    ds_read_b64_tr_b16 v[64:65], v9 offset:8192
    v_mfma_f32_16x16x32_bf16 v[40:43], v[84:87], v[104:107], v[40:43]
    ds_read_b64_tr_b16 v[66:67], v9 offset:9216
    v_mfma_f32_16x16x32_bf16 v[44:47], v[84:87], v[108:111], v[44:47]
    ds_read_b64_tr_b16 v[68:69], v10 offset:8192
    v_mfma_f32_16x16x32_bf16 v[48:51], v[88:91], v[104:107], v[48:51]
    ds_read_b64_tr_b16 v[70:71], v10 offset:9216
    ds_read_b64_tr_b16 v[72:73], v11 offset:8192
    v_mfma_f32_16x16x32_bf16 v[52:55], v[88:91], v[108:111], v[52:55]
    ds_read_b64_tr_b16 v[74:75], v11 offset:9216
    v_mfma_f32_16x16x32_bf16 v[56:59], v[92:95], v[104:107], v[56:59]
    ds_read_b64_tr_b16 v[76:77], v12 offset:8192
    v_mfma_f32_16x16x32_bf16 v[60:63], v[92:95], v[108:111], v[60:63]
    ds_read_b64_tr_b16 v[78:79], v12 offset:9216
    s_waitcnt lgkmcnt(0)
    v_mfma_f32_16x16x32_bf16 v[32:35], v[64:67], v[96:99], v[32:35]
    ds_read_b128 v[104:107], v6 offset:24576
    ds_read_b128 v[108:111], v6 offset:25600
    v_mfma_f32_16x16x32_bf16 v[36:39], v[64:67], v[100:103], v[36:39]
    ds_read_b64_tr_b16 v[80:81], v9 offset:12288
    v_mfma_f32_16x16x32_bf16 v[40:43], v[68:71], v[96:99], v[40:43]
    ds_read_b64_tr_b16 v[82:83], v9 offset:13312
    v_mfma_f32_16x16x32_bf16 v[44:47], v[68:71], v[100:103], v[44:47]
    ds_read_b64_tr_b16 v[84:85], v10 offset:12288
    v_mfma_f32_16x16x32_bf16 v[48:51], v[72:75], v[96:99], v[48:51]
    ds_read_b64_tr_b16 v[86:87], v10 offset:13312
    ds_read_b64_tr_b16 v[88:89], v11 offset:12288
    v_mfma_f32_16x16x32_bf16 v[52:55], v[72:75], v[100:103], v[52:55]
    ds_read_b64_tr_b16 v[90:91], v11 offset:13312
    v_mfma_f32_16x16x32_bf16 v[56:59], v[76:79], v[96:99], v[56:59]
    ds_read_b64_tr_b16 v[92:93], v12 offset:12288
    v_mfma_f32_16x16x32_bf16 v[60:63], v[76:79], v[100:103], v[60:63]
    ds_read_b64_tr_b16 v[94:95], v12 offset:13312
    s_waitcnt vmcnt(9) lgkmcnt(0)
    s_barrier
    v_mfma_f32_16x16x32_bf16 v[32:35], v[80:83], v[104:107], v[32:35]
    ds_read_b128 v[96:99], v7 offset:0
    ds_read_b128 v[100:103], v7 offset:1024
    v_mfma_f32_16x16x32_bf16 v[36:39], v[80:83], v[108:111], v[36:39]
    ds_read_b64_tr_b16 v[64:65], v13 offset:0
    v_mfma_f32_16x16x32_bf16 v[40:43], v[84:87], v[104:107], v[40:43]
    ds_read_b64_tr_b16 v[66:67], v13 offset:1024
    v_mfma_f32_16x16x32_bf16 v[44:47], v[84:87], v[108:111], v[44:47]
    ds_read_b64_tr_b16 v[68:69], v14 offset:0
    v_mfma_f32_16x16x32_bf16 v[48:51], v[88:91], v[104:107], v[48:51]
    ds_read_b64_tr_b16 v[70:71], v14 offset:1024
    ds_read_b64_tr_b16 v[72:73], v15 offset:0
    v_mfma_f32_16x16x32_bf16 v[52:55], v[88:91], v[108:111], v[52:55]
    ds_read_b64_tr_b16 v[74:75], v15 offset:1024
    v_mfma_f32_16x16x32_bf16 v[56:59], v[92:95], v[104:107], v[56:59]
    ds_read_b64_tr_b16 v[76:77], v16 offset:0
    v_mfma_f32_16x16x32_bf16 v[60:63], v[92:95], v[108:111], v[60:63]
    ds_read_b64_tr_b16 v[78:79], v16 offset:1024
    s_waitcnt lgkmcnt(0)
    v_mfma_f32_16x16x32_bf16 v[32:35], v[64:67], v[96:99], v[32:35]
    ds_read_b128 v[104:107], v7 offset:8192
    ds_read_b128 v[108:111], v7 offset:9216
    v_mfma_f32_16x16x32_bf16 v[36:39], v[64:67], v[100:103], v[36:39]
    ds_read_b64_tr_b16 v[80:81], v13 offset:4096
    v_mfma_f32_16x16x32_bf16 v[40:43], v[68:71], v[96:99], v[40:43]
    ds_read_b64_tr_b16 v[82:83], v13 offset:5120
    v_mfma_f32_16x16x32_bf16 v[44:47], v[68:71], v[100:103], v[44:47]
    ds_read_b64_tr_b16 v[84:85], v14 offset:4096
    v_mfma_f32_16x16x32_bf16 v[48:51], v[72:75], v[96:99], v[48:51]
    ds_read_b64_tr_b16 v[86:87], v14 offset:5120
    ds_read_b64_tr_b16 v[88:89], v15 offset:4096
    v_mfma_f32_16x16x32_bf16 v[52:55], v[72:75], v[100:103], v[52:55]
    ds_read_b64_tr_b16 v[90:91], v15 offset:5120
    v_mfma_f32_16x16x32_bf16 v[56:59], v[76:79], v[96:99], v[56:59]
    ds_read_b64_tr_b16 v[92:93], v16 offset:4096
    v_mfma_f32_16x16x32_bf16 v[60:63], v[76:79], v[100:103], v[60:63]
    ds_read_b64_tr_b16 v[94:95], v16 offset:5120
    s_waitcnt lgkmcnt(0)
    v_mfma_f32_16x16x32_bf16 v[32:35], v[80:83], v[104:107], v[32:35]
    ds_read_b128 v[96:99], v7 offset:16384
    ds_read_b128 v[100:103], v7 offset:17408
    v_mfma_f32_16x16x32_bf16 v[36:39], v[80:83], v[108:111], v[36:39]
    ds_read_b64_tr_b16 v[64:65], v13 offset:8192
    v_mfma_f32_16x16x32_bf16 v[40:43], v[84:87], v[104:107], v[40:43]
    ds_read_b64_tr_b16 v[66:67], v13 offset:9216
    v_mfma_f32_16x16x32_bf16 v[44:47], v[84:87], v[108:111], v[44:47]
    ds_read_b64_tr_b16 v[68:69], v14 offset:8192
    v_mfma_f32_16x16x32_bf16 v[48:51], v[88:91], v[104:107], v[48:51]
    ds_read_b64_tr_b16 v[70:71], v14 offset:9216
    ds_read_b64_tr_b16 v[72:73], v15 offset:8192
    v_mfma_f32_16x16x32_bf16 v[52:55], v[88:91], v[108:111], v[52:55]
    ds_read_b64_tr_b16 v[74:75], v15 offset:9216
    v_mfma_f32_16x16x32_bf16 v[56:59], v[92:95], v[104:107], v[56:59]
    ds_read_b64_tr_b16 v[76:77], v16 offset:8192
    v_mfma_f32_16x16x32_bf16 v[60:63], v[92:95], v[108:111], v[60:63]
    ds_read_b64_tr_b16 v[78:79], v16 offset:9216
    s_waitcnt lgkmcnt(0)
    v_mfma_f32_16x16x32_bf16 v[32:35], v[64:67], v[96:99], v[32:35]
    ds_read_b128 v[104:107], v7 offset:24576
    ds_read_b128 v[108:111], v7 offset:25600
    v_mfma_f32_16x16x32_bf16 v[36:39], v[64:67], v[100:103], v[36:39]
    ds_read_b64_tr_b16 v[80:81], v13 offset:12288
    v_mfma_f32_16x16x32_bf16 v[40:43], v[68:71], v[96:99], v[40:43]
    ds_read_b64_tr_b16 v[82:83], v13 offset:13312
    v_mfma_f32_16x16x32_bf16 v[44:47], v[68:71], v[100:103], v[44:47]
    ds_read_b64_tr_b16 v[84:85], v14 offset:12288
    v_mfma_f32_16x16x32_bf16 v[48:51], v[72:75], v[96:99], v[48:51]
    ds_read_b64_tr_b16 v[86:87], v14 offset:13312
    ds_read_b64_tr_b16 v[88:89], v15 offset:12288
    v_mfma_f32_16x16x32_bf16 v[52:55], v[72:75], v[100:103], v[52:55]
    ds_read_b64_tr_b16 v[90:91], v15 offset:13312
    v_mfma_f32_16x16x32_bf16 v[56:59], v[76:79], v[96:99], v[56:59]
    ds_read_b64_tr_b16 v[92:93], v16 offset:12288
    v_mfma_f32_16x16x32_bf16 v[60:63], v[76:79], v[100:103], v[60:63]
    ds_read_b64_tr_b16 v[94:95], v16 offset:13312
    s_waitcnt lgkmcnt(0)
    v_mfma_f32_16x16x32_bf16 v[32:35], v[80:83], v[104:107], v[32:35]
    v_mfma_f32_16x16x32_bf16 v[36:39], v[80:83], v[108:111], v[36:39]
    v_mfma_f32_16x16x32_bf16 v[40:43], v[84:87], v[104:107], v[40:43]
    v_mfma_f32_16x16x32_bf16 v[44:47], v[84:87], v[108:111], v[44:47]
    v_mfma_f32_16x16x32_bf16 v[48:51], v[88:91], v[104:107], v[48:51]
    v_mfma_f32_16x16x32_bf16 v[52:55], v[88:91], v[108:111], v[52:55]
    v_mfma_f32_16x16x32_bf16 v[56:59], v[92:95], v[104:107], v[56:59]
    v_mfma_f32_16x16x32_bf16 v[60:63], v[92:95], v[108:111], v[60:63]
    s_waitcnt vmcnt(1)
    v_lshlrev_b32 v64, 16, v112
    v_and_b32 v65, 0xffff0000, v112
    v_lshlrev_b32 v66, 16, v113
    v_and_b32 v67, 0xffff0000, v113
    v_pk_add_f32 v[32:33], v[64:65], v[32:33]
    v_pk_add_f32 v[34:35], v[66:67], v[34:35]
    v_cvt_pk_bf16_f32 v72, v32, v33
    v_cvt_pk_bf16_f32 v73, v34, v35
    v_lshlrev_b32 v68, 16, v114
    v_and_b32 v69, 0xffff0000, v114
    v_lshlrev_b32 v70, 16, v115
    v_and_b32 v71, 0xffff0000, v115
    v_pk_add_f32 v[40:41], v[68:69], v[40:41]
    v_pk_add_f32 v[42:43], v[70:71], v[42:43]
    v_cvt_pk_bf16_f32 v74, v40, v41
    v_cvt_pk_bf16_f32 v75, v42, v43
    buffer_store_dwordx4 v[72:75], v1, s[8:11], s35 offen offset:0 sc1
    v_lshlrev_b32 v64, 16, v116
    v_and_b32 v65, 0xffff0000, v116
    v_lshlrev_b32 v66, 16, v117
    v_and_b32 v67, 0xffff0000, v117
    v_pk_add_f32 v[48:49], v[64:65], v[48:49]
    v_pk_add_f32 v[50:51], v[66:67], v[50:51]
    v_cvt_pk_bf16_f32 v76, v48, v49
    v_cvt_pk_bf16_f32 v77, v50, v51
    v_lshlrev_b32 v68, 16, v118
    v_and_b32 v69, 0xffff0000, v118
    v_lshlrev_b32 v70, 16, v119
    v_and_b32 v71, 0xffff0000, v119
    v_pk_add_f32 v[56:57], v[68:69], v[56:57]
    v_pk_add_f32 v[58:59], v[70:71], v[58:59]
    v_cvt_pk_bf16_f32 v78, v56, v57
    v_cvt_pk_bf16_f32 v79, v58, v59
    buffer_store_dwordx4 v[76:79], v1, s[8:11], s36 offen offset:0 sc1
    v_lshlrev_b32 v64, 16, v120
    v_and_b32 v65, 0xffff0000, v120
    v_lshlrev_b32 v66, 16, v121
    v_and_b32 v67, 0xffff0000, v121
    v_pk_add_f32 v[36:37], v[64:65], v[36:37]
    v_pk_add_f32 v[38:39], v[66:67], v[38:39]
    v_cvt_pk_bf16_f32 v80, v36, v37
    v_cvt_pk_bf16_f32 v81, v38, v39
    v_lshlrev_b32 v68, 16, v122
    v_and_b32 v69, 0xffff0000, v122
    v_lshlrev_b32 v70, 16, v123
    v_and_b32 v71, 0xffff0000, v123
    v_pk_add_f32 v[44:45], v[68:69], v[44:45]
    v_pk_add_f32 v[46:47], v[70:71], v[46:47]
    v_cvt_pk_bf16_f32 v82, v44, v45
    v_cvt_pk_bf16_f32 v83, v46, v47
    buffer_store_dwordx4 v[80:83], v1, s[8:11], s35 offen offset:1024 sc1
    v_lshlrev_b32 v64, 16, v124
    v_and_b32 v65, 0xffff0000, v124
    v_lshlrev_b32 v66, 16, v125
    v_and_b32 v67, 0xffff0000, v125
    v_pk_add_f32 v[52:53], v[64:65], v[52:53]
    v_pk_add_f32 v[54:55], v[66:67], v[54:55]
    v_cvt_pk_bf16_f32 v84, v52, v53
    v_cvt_pk_bf16_f32 v85, v54, v55
    v_lshlrev_b32 v68, 16, v126
    v_and_b32 v69, 0xffff0000, v126
    v_lshlrev_b32 v70, 16, v127
    v_and_b32 v71, 0xffff0000, v127
    v_pk_add_f32 v[60:61], v[68:69], v[60:61]
    v_pk_add_f32 v[62:63], v[70:71], v[62:63]
    v_cvt_pk_bf16_f32 v86, v60, v61
    v_cvt_pk_bf16_f32 v87, v62, v63
    buffer_store_dwordx4 v[84:87], v1, s[8:11], s36 offen offset:1024 sc1
    v_lshlrev_b32 v32, 16, v72
    v_lshlrev_b32 v36, 16, v80
    v_and_b32 v33, 0xffff0000, v72
    v_and_b32 v37, 0xffff0000, v80
    v_lshlrev_b32 v34, 16, v73
    v_lshlrev_b32 v38, 16, v81
    v_and_b32 v35, 0xffff0000, v73
    v_and_b32 v39, 0xffff0000, v81
    v_lshlrev_b32 v40, 16, v74
    v_lshlrev_b32 v44, 16, v82
    v_and_b32 v41, 0xffff0000, v74
    v_and_b32 v45, 0xffff0000, v82
    v_lshlrev_b32 v42, 16, v75
    v_lshlrev_b32 v46, 16, v83
    v_and_b32 v43, 0xffff0000, v75
    v_and_b32 v47, 0xffff0000, v83
    v_lshlrev_b32 v48, 16, v76
    v_lshlrev_b32 v52, 16, v84
    v_and_b32 v49, 0xffff0000, v76
    v_and_b32 v53, 0xffff0000, v84
    v_lshlrev_b32 v50, 16, v77
    v_lshlrev_b32 v54, 16, v85
    v_and_b32 v51, 0xffff0000, v77
    v_and_b32 v55, 0xffff0000, v85
    v_lshlrev_b32 v56, 16, v78
    v_lshlrev_b32 v60, 16, v86
    v_and_b32 v57, 0xffff0000, v78
    v_and_b32 v61, 0xffff0000, v86
    v_lshlrev_b32 v58, 16, v79
    v_lshlrev_b32 v62, 16, v87
    v_and_b32 v59, 0xffff0000, v79
    v_and_b32 v63, 0xffff0000, v87
    v_pk_add_f32 v[88:89], v[32:33], v[34:35]
    v_pk_add_f32 v[96:97], v[36:37], v[38:39]
    v_pk_add_f32 v[90:91], v[40:41], v[42:43]
    v_pk_add_f32 v[98:99], v[44:45], v[46:47]
    v_pk_add_f32 v[92:93], v[48:49], v[50:51]
    v_pk_add_f32 v[100:101], v[52:53], v[54:55]
    v_pk_add_f32 v[94:95], v[56:57], v[58:59]
    v_pk_add_f32 v[102:103], v[60:61], v[62:63]
    v_pk_add_f32 v[88:89], v[88:89], v[90:91]
    v_pk_add_f32 v[96:97], v[96:97], v[98:99]
    v_pk_add_f32 v[92:93], v[92:93], v[94:95]
    v_pk_add_f32 v[100:101], v[100:101], v[102:103]
    v_pk_add_f32 v[88:89], v[88:89], v[92:93]
    v_pk_add_f32 v[96:97], v[96:97], v[100:101]
    v_add_f32 v4, v88, v89
    v_add_f32 v5, v96, v97
    v_mov_b32 v108, v4
    v_mov_b32 v109, v5
    s_nop 0
    v_permlane16_swap_b32 v4, v108
    v_permlane16_swap_b32 v5, v109
    v_add_f32 v4, v4, v108
    v_add_f32 v5, v5, v109
    v_mov_b32 v108, v4
    v_mov_b32 v109, v5
    s_nop 0
    v_permlane32_swap_b32 v4, v108
    v_permlane32_swap_b32 v5, v109
    v_add_f32 v4, v4, v108
    v_add_f32 v5, v5, v109
    v_mul_f32 v104, 0xbc800000, v4
    v_mul_f32 v106, 0xbc800000, v5
    v_pk_add_f32 v[32:33], v[32:33], v[104:105] op_sel_hi:[1,0]
    v_pk_add_f32 v[36:37], v[36:37], v[106:107] op_sel_hi:[1,0]
    v_pk_add_f32 v[34:35], v[34:35], v[104:105] op_sel_hi:[1,0]
    v_pk_add_f32 v[38:39], v[38:39], v[106:107] op_sel_hi:[1,0]
    v_pk_add_f32 v[40:41], v[40:41], v[104:105] op_sel_hi:[1,0]
    v_pk_add_f32 v[44:45], v[44:45], v[106:107] op_sel_hi:[1,0]
    v_pk_add_f32 v[42:43], v[42:43], v[104:105] op_sel_hi:[1,0]
    v_pk_add_f32 v[46:47], v[46:47], v[106:107] op_sel_hi:[1,0]
    v_pk_add_f32 v[48:49], v[48:49], v[104:105] op_sel_hi:[1,0]
    v_pk_add_f32 v[52:53], v[52:53], v[106:107] op_sel_hi:[1,0]
    v_pk_add_f32 v[50:51], v[50:51], v[104:105] op_sel_hi:[1,0]
    v_pk_add_f32 v[54:55], v[54:55], v[106:107] op_sel_hi:[1,0]
    v_pk_add_f32 v[56:57], v[56:57], v[104:105] op_sel_hi:[1,0]
    v_pk_add_f32 v[60:61], v[60:61], v[106:107] op_sel_hi:[1,0]
    v_pk_add_f32 v[58:59], v[58:59], v[104:105] op_sel_hi:[1,0]
    v_pk_add_f32 v[62:63], v[62:63], v[106:107] op_sel_hi:[1,0]
    v_pk_mul_f32 v[88:89], v[32:33], v[32:33]
    v_pk_mul_f32 v[96:97], v[36:37], v[36:37]
    v_pk_mul_f32 v[90:91], v[34:35], v[34:35]
    v_pk_mul_f32 v[98:99], v[38:39], v[38:39]
    v_pk_fma_f32 v[88:89], v[40:41], v[40:41], v[88:89]
    v_pk_fma_f32 v[96:97], v[44:45], v[44:45], v[96:97]
    v_pk_fma_f32 v[90:91], v[42:43], v[42:43], v[90:91]
    v_pk_fma_f32 v[98:99], v[46:47], v[46:47], v[98:99]
    v_pk_fma_f32 v[88:89], v[48:49], v[48:49], v[88:89]
    v_pk_fma_f32 v[96:97], v[52:53], v[52:53], v[96:97]
    v_pk_fma_f32 v[90:91], v[50:51], v[50:51], v[90:91]
    v_pk_fma_f32 v[98:99], v[54:55], v[54:55], v[98:99]
    v_pk_fma_f32 v[88:89], v[56:57], v[56:57], v[88:89]
    v_pk_fma_f32 v[96:97], v[60:61], v[60:61], v[96:97]
    v_pk_fma_f32 v[90:91], v[58:59], v[58:59], v[90:91]
    v_pk_fma_f32 v[98:99], v[62:63], v[62:63], v[98:99]
    v_pk_add_f32 v[88:89], v[88:89], v[90:91]
    v_pk_add_f32 v[96:97], v[96:97], v[98:99]
    v_add_f32 v6, v88, v89
    v_add_f32 v7, v96, v97
    v_mov_b32 v108, v6
    v_mov_b32 v109, v7
    s_nop 0
    v_permlane16_swap_b32 v6, v108
    v_permlane16_swap_b32 v7, v109
    v_add_f32 v6, v6, v108
    v_add_f32 v7, v7, v109
    v_mov_b32 v108, v6
    v_mov_b32 v109, v7
    s_nop 0
    v_permlane32_swap_b32 v6, v108
    v_permlane32_swap_b32 v7, v109
    v_add_f32 v6, v6, v108
    v_add_f32 v7, v7, v109
    v_bfe_u32 v8, v0, 4, 1
    v_cmp_ne_u32 vcc, 0, v8
    s_nop 1
    v_cndmask_b32 v10, v4, v5, vcc
    v_cndmask_b32 v11, v6, v7, vcc
    v_and_b32 v9, 15, v0
    v_lshl_add_u32 v9, v9, 1, v8
    v_lshlrev_b32 v9, 3, v9
    s_lshl_b32 s38, s19, 14
    s_lshl_b32 s39, s32, 7
    s_add_u32 s38, s38, s39
    s_add_u32 s38, s38, 25165824
    buffer_store_dwordx2 v[10:11], v9, s[8:11], s38 offen sc1
K3_END:
    s_endpgm
.globl gu_kernel
.p2align 8
.type gu_kernel,@function
gu_kernel:
    s_cmp_ge_u32 s2, 256
    s_cbranch_scc1 K4_END
    s_load_dwordx2 s[40:41], s[0:1], 72
    v_lshrrev_b32 v1, 6, v0
    v_and_b32 v0, 63, v0
    v_readfirstlane_b32 s3, v1
    s_nop 0
    s_cmp_lg_u32 s3, 0
    s_cbranch_scc1 CPF11_X
    v_min_u32 v2, 3, v0
    s_lshr_b32 s62, s2, 3
    s_mul_i32 s62, s62, 512
    v_lshl_add_u32 v2, v2, 7, s62
    v_min_u32 v2, TEXT_END-CPF11-4, v2
    s_getpc_b64 s[62:63]
CPF11:
    v_mov_b32 v3, s63
    v_add_co_u32 v2, vcc, s62, v2
    s_nop 1
    v_addc_co_u32 v3, vcc, 0, v3, vcc
    global_load_dword v236, v[2:3], off
CPF11_X:
    s_and_b32 s16, s2, 7
    s_lshr_b32 s17, s2, 3
    s_and_b32 s18, s16, 1
    s_lshl_b32 s18, s18, 2
    s_and_b32 s19, s17, 3
    s_add_u32 s18, s18, s19
    s_lshr_b32 s19, s16, 1
    s_lshl_b32 s19, s19, 3
    s_lshr_b32 s20, s17, 2
    s_add_u32 s19, s19, s20
    s_lshl_b32 s24, s18, 4
    s_lshl_b32 s25, s3, 2
    s_add_u32 s24, s24, s25
    s_lshl_b32 s24, s24, 10
    s_add_u32 s24, s24, 20971520
    s_lshl_b32 s26, s3, 12
    s_sub_u32 s27, s25, 16
    s_min_u32 s27, s27, 10
    s_mul_i32 s28, s19, 448
    s_add_u32 s28, s28, s27
    s_lshl_b32 s28, s28, 10
    s_add_u32 s28, s28, 26214400
    s_lshl_b32 s27, s27, 10
    s_add_u32 s27, s27, 16384
    s_movk_i32 s31, 14336
    s_cmp_lt_u32 s3, 4
    s_cselect_b32 s24, s24, s28
    s_cselect_b32 s26, s26, s27
    s_cselect_b32 s25, 131072, s31
    v_lshlrev_b32 v1, 4, v0
    v_add_u32 v2, 61440, v1
    s_lshl_b32 s29, s3, 11
    v_add_u32 v3, s29, v1
    v_add_u32 v4, 61440, v3
    s_waitcnt lgkmcnt(0)
    s_mov_b32 s8, s40
    s_mov_b32 s9, s41
    s_mov_b32 s10, 0x10000000
    s_mov_b32 s11, 0x00020000
    s_add_u32 m0, s26, 0
    s_nop 0
    buffer_load_dwordx4 v1, s[8:11], s24 offen offset:0 lds
    buffer_load_dwordx4 v1, s[8:11], s24 offen offset:1024 lds
    buffer_load_dwordx4 v1, s[8:11], s24 offen offset:2048 lds
    buffer_load_dwordx4 v1, s[8:11], s24 offen offset:3072 lds
    s_add_u32 s24, s24, s25
    v_lshrrev_b32 v5, 4, v0
    v_lshlrev_b32 v5, 16, v5
    v_and_b32 v15, 15, v0
    v_lshl_add_u32 v5, v15, 4, v5
    s_lshl_b32 s50, s18, 11
    s_lshl_b32 s22, s3, 8
    s_add_u32 s50, s50, s22
    s_add_u32 s50, s50, 25165824
    s_lshl_b32 s51, s3, 12
    s_add_u32 s51, s51, 124928
    s_mul_i32 s52, s19, 896
    s_mul_i32 s22, s3, 28672
    s_add_u32 s52, s52, s22
    s_add_u32 s52, s52, 25690112
    s_lshl_b32 s53, s3, 10
    s_barrier
    s_add_u32 m0, s26, 30720
    s_nop 0
    buffer_load_dwordx4 v1, s[8:11], s24 offen offset:0 lds
    buffer_load_dwordx4 v1, s[8:11], s24 offen offset:1024 lds
    buffer_load_dwordx4 v1, s[8:11], s24 offen offset:2048 lds
    buffer_load_dwordx4 v1, s[8:11], s24 offen offset:3072 lds
    s_add_u32 s24, s24, s25
    s_add_u32 m0, s26, 61440
    s_nop 0
    buffer_load_dwordx4 v1, s[8:11], s24 offen offset:0 lds
    buffer_load_dwordx4 v1, s[8:11], s24 offen offset:1024 lds
    buffer_load_dwordx4 v1, s[8:11], s24 offen offset:2048 lds
    buffer_load_dwordx4 v1, s[8:11], s24 offen offset:3072 lds
    s_add_u32 s24, s24, s25
    s_mov_b32 s61, 0x3c800000
    s_waitcnt vmcnt(8)
    s_barrier
    ds_read_b128 v[240:243], v3 offset:0
    ds_read_b128 v[244:247], v3 offset:1024
    ds_read_b128 v[128:131], v1 offset:16384
    ds_read_b128 v[132:135], v1 offset:17408
    ds_read_b128 v[136:139], v1 offset:18432
    ds_read_b128 v[140:143], v1 offset:19456
    ds_read_b128 v[144:147], v1 offset:20480
    ds_read_b128 v[148:151], v1 offset:21504
    ds_read_b128 v[152:155], v1 offset:22528
    ds_read_b128 v[156:159], v1 offset:23552
    ds_read_b128 v[160:163], v1 offset:24576
    ds_read_b128 v[164:167], v1 offset:25600
    ds_read_b128 v[168:171], v1 offset:26624
    ds_read_b128 v[172:175], v1 offset:27648
    ds_read_b128 v[176:179], v1 offset:28672
    ds_read_b128 v[180:183], v1 offset:29696
    s_add_u32 m0, s26, 92160
    s_nop 0
    buffer_load_dwordx4 v1, s[8:11], s24 offen offset:0 lds
    buffer_load_dwordx4 v1, s[8:11], s24 offen offset:1024 lds
    buffer_load_dwordx4 v1, s[8:11], s24 offen offset:2048 lds
    buffer_load_dwordx4 v1, s[8:11], s24 offen offset:3072 lds
    s_add_u32 s24, s24, s25
    s_waitcnt lgkmcnt(13)
    v_mfma_f32_16x16x32_bf16 v[16:19], v[128:131], v[240:243], 0
    v_mfma_f32_16x16x32_bf16 v[20:23], v[128:131], v[244:247], 0
    s_waitcnt lgkmcnt(12)
    v_mfma_f32_16x16x32_bf16 v[24:27], v[132:135], v[240:243], 0
    v_mfma_f32_16x16x32_bf16 v[28:31], v[132:135], v[244:247], 0
    s_waitcnt lgkmcnt(11)
    v_mfma_f32_16x16x32_bf16 v[32:35], v[136:139], v[240:243], 0
    v_mfma_f32_16x16x32_bf16 v[36:39], v[136:139], v[244:247], 0
    s_waitcnt lgkmcnt(10)
    v_mfma_f32_16x16x32_bf16 v[40:43], v[140:143], v[240:243], 0
    v_mfma_f32_16x16x32_bf16 v[44:47], v[140:143], v[244:247], 0
    s_waitcnt lgkmcnt(9)
    v_mfma_f32_16x16x32_bf16 v[48:51], v[144:147], v[240:243], 0
    v_mfma_f32_16x16x32_bf16 v[52:55], v[144:147], v[244:247], 0
    s_waitcnt lgkmcnt(8)
    v_mfma_f32_16x16x32_bf16 v[56:59], v[148:151], v[240:243], 0
    v_mfma_f32_16x16x32_bf16 v[60:63], v[148:151], v[244:247], 0
    s_waitcnt vmcnt(8) lgkmcnt(0)
    s_barrier
    v_mfma_f32_16x16x32_bf16 v[64:67], v[152:155], v[240:243], 0
    ds_read_b128 v[248:251], v3 offset:30720
    v_mfma_f32_16x16x32_bf16 v[68:71], v[152:155], v[244:247], 0
    ds_read_b128 v[252:255], v3 offset:31744
    v_mfma_f32_16x16x32_bf16 v[72:75], v[156:159], v[240:243], 0
    ds_read_b128 v[184:187], v1 offset:47104
    v_mfma_f32_16x16x32_bf16 v[76:79], v[156:159], v[244:247], 0
    ds_read_b128 v[188:191], v1 offset:48128
    v_mfma_f32_16x16x32_bf16 v[80:83], v[160:163], v[240:243], 0
    ds_read_b128 v[192:195], v1 offset:49152
    v_mfma_f32_16x16x32_bf16 v[84:87], v[160:163], v[244:247], 0
    s_add_u32 m0, s26, 0
    ds_read_b128 v[196:199], v1 offset:50176
    v_mfma_f32_16x16x32_bf16 v[88:91], v[164:167], v[240:243], 0
    ds_read_b128 v[200:203], v1 offset:51200
    buffer_load_dwordx4 v1, s[8:11], s24 offen offset:0 lds
    v_mfma_f32_16x16x32_bf16 v[92:95], v[164:167], v[244:247], 0
    ds_read_b128 v[204:207], v1 offset:52224
    v_mfma_f32_16x16x32_bf16 v[96:99], v[168:171], v[240:243], 0
    ds_read_b128 v[208:211], v1 offset:53248
    buffer_load_dwordx4 v1, s[8:11], s24 offen offset:1024 lds
    v_mfma_f32_16x16x32_bf16 v[100:103], v[168:171], v[244:247], 0
    ds_read_b128 v[212:215], v1 offset:54272
    v_mfma_f32_16x16x32_bf16 v[104:107], v[172:175], v[240:243], 0
    ds_read_b128 v[216:219], v1 offset:55296
    buffer_load_dwordx4 v1, s[8:11], s24 offen offset:2048 lds
    v_mfma_f32_16x16x32_bf16 v[108:111], v[172:175], v[244:247], 0
    ds_read_b128 v[220:223], v1 offset:56320
    v_mfma_f32_16x16x32_bf16 v[112:115], v[176:179], v[240:243], 0
    ds_read_b128 v[224:227], v1 offset:57344
    buffer_load_dwordx4 v1, s[8:11], s24 offen offset:3072 lds
    s_add_u32 s24, s24, s25
    v_mfma_f32_16x16x32_bf16 v[116:119], v[176:179], v[244:247], 0
    ds_read_b128 v[228:231], v1 offset:58368
    v_mfma_f32_16x16x32_bf16 v[120:123], v[180:183], v[240:243], 0
    ds_read_b128 v[232:235], v1 offset:59392
    v_mfma_f32_16x16x32_bf16 v[124:127], v[180:183], v[244:247], 0
    ds_read_b128 v[236:239], v1 offset:60416
    s_waitcnt vmcnt(8) lgkmcnt(0)
    s_barrier
    v_mfma_f32_16x16x32_bf16 v[16:19], v[184:187], v[248:251], v[16:19]
    ds_read_b128 v[240:243], v4 offset:0
    v_mfma_f32_16x16x32_bf16 v[20:23], v[184:187], v[252:255], v[20:23]
    ds_read_b128 v[244:247], v4 offset:1024
    v_mfma_f32_16x16x32_bf16 v[24:27], v[188:191], v[248:251], v[24:27]
    ds_read_b128 v[128:131], v2 offset:16384
    v_mfma_f32_16x16x32_bf16 v[28:31], v[188:191], v[252:255], v[28:31]
    ds_read_b128 v[132:135], v2 offset:17408
    v_mfma_f32_16x16x32_bf16 v[32:35], v[192:195], v[248:251], v[32:35]
    ds_read_b128 v[136:139], v2 offset:18432
    v_mfma_f32_16x16x32_bf16 v[36:39], v[192:195], v[252:255], v[36:39]
    ds_read_b128 v[140:143], v2 offset:19456
    v_mfma_f32_16x16x32_bf16 v[40:43], v[196:199], v[248:251], v[40:43]
    ds_read_b128 v[144:147], v2 offset:20480
    v_mfma_f32_16x16x32_bf16 v[44:47], v[196:199], v[252:255], v[44:47]
    ds_read_b128 v[148:151], v2 offset:21504
    v_mfma_f32_16x16x32_bf16 v[48:51], v[200:203], v[248:251], v[48:51]
    ds_read_b128 v[152:155], v2 offset:22528
    v_mfma_f32_16x16x32_bf16 v[52:55], v[200:203], v[252:255], v[52:55]
    ds_read_b128 v[156:159], v2 offset:23552
    v_mfma_f32_16x16x32_bf16 v[56:59], v[204:207], v[248:251], v[56:59]
    ds_read_b128 v[160:163], v2 offset:24576
    v_mfma_f32_16x16x32_bf16 v[60:63], v[204:207], v[252:255], v[60:63]
    ds_read_b128 v[164:167], v2 offset:25600
    v_mfma_f32_16x16x32_bf16 v[64:67], v[208:211], v[248:251], v[64:67]
    ds_read_b128 v[168:171], v2 offset:26624
    v_mfma_f32_16x16x32_bf16 v[68:71], v[208:211], v[252:255], v[68:71]
    ds_read_b128 v[172:175], v2 offset:27648
    v_mfma_f32_16x16x32_bf16 v[72:75], v[212:215], v[248:251], v[72:75]
    ds_read_b128 v[176:179], v2 offset:28672
    v_mfma_f32_16x16x32_bf16 v[76:79], v[212:215], v[252:255], v[76:79]
    ds_read_b128 v[180:183], v2 offset:29696
    v_mfma_f32_16x16x32_bf16 v[80:83], v[216:219], v[248:251], v[80:83]
    v_mfma_f32_16x16x32_bf16 v[84:87], v[216:219], v[252:255], v[84:87]
    s_add_u32 m0, s26, 30720
    v_mfma_f32_16x16x32_bf16 v[88:91], v[220:223], v[248:251], v[88:91]
    buffer_load_dwordx4 v1, s[8:11], s24 offen offset:0 lds
    v_mfma_f32_16x16x32_bf16 v[92:95], v[220:223], v[252:255], v[92:95]
    v_mfma_f32_16x16x32_bf16 v[96:99], v[224:227], v[248:251], v[96:99]
    buffer_load_dwordx4 v1, s[8:11], s24 offen offset:1024 lds
    v_mfma_f32_16x16x32_bf16 v[100:103], v[224:227], v[252:255], v[100:103]
    v_mfma_f32_16x16x32_bf16 v[104:107], v[228:231], v[248:251], v[104:107]
    buffer_load_dwordx4 v1, s[8:11], s24 offen offset:2048 lds
    v_mfma_f32_16x16x32_bf16 v[108:111], v[228:231], v[252:255], v[108:111]
    v_mfma_f32_16x16x32_bf16 v[112:115], v[232:235], v[248:251], v[112:115]
    buffer_load_dwordx4 v1, s[8:11], s24 offen offset:3072 lds
    s_add_u32 s24, s24, s25
    v_mfma_f32_16x16x32_bf16 v[116:119], v[232:235], v[252:255], v[116:119]
    v_mfma_f32_16x16x32_bf16 v[120:123], v[236:239], v[248:251], v[120:123]
    v_mfma_f32_16x16x32_bf16 v[124:127], v[236:239], v[252:255], v[124:127]
    s_waitcnt vmcnt(8) lgkmcnt(0)
    s_barrier
    v_mfma_f32_16x16x32_bf16 v[16:19], v[128:131], v[240:243], v[16:19]
    ds_read_b128 v[248:251], v4 offset:30720
    v_mfma_f32_16x16x32_bf16 v[20:23], v[128:131], v[244:247], v[20:23]
    ds_read_b128 v[252:255], v4 offset:31744
    v_mfma_f32_16x16x32_bf16 v[24:27], v[132:135], v[240:243], v[24:27]
    ds_read_b128 v[184:187], v2 offset:47104
    v_mfma_f32_16x16x32_bf16 v[28:31], v[132:135], v[244:247], v[28:31]
    ds_read_b128 v[188:191], v2 offset:48128
    v_mfma_f32_16x16x32_bf16 v[32:35], v[136:139], v[240:243], v[32:35]
    ds_read_b128 v[192:195], v2 offset:49152
    v_mfma_f32_16x16x32_bf16 v[36:39], v[136:139], v[244:247], v[36:39]
    ds_read_b128 v[196:199], v2 offset:50176
    v_mfma_f32_16x16x32_bf16 v[40:43], v[140:143], v[240:243], v[40:43]
    ds_read_b128 v[200:203], v2 offset:51200
    v_mfma_f32_16x16x32_bf16 v[44:47], v[140:143], v[244:247], v[44:47]
    ds_read_b128 v[204:207], v2 offset:52224
    v_mfma_f32_16x16x32_bf16 v[48:51], v[144:147], v[240:243], v[48:51]
    ds_read_b128 v[208:211], v2 offset:53248
    v_mfma_f32_16x16x32_bf16 v[52:55], v[144:147], v[244:247], v[52:55]
    ds_read_b128 v[212:215], v2 offset:54272
    v_mfma_f32_16x16x32_bf16 v[56:59], v[148:151], v[240:243], v[56:59]
    ds_read_b128 v[216:219], v2 offset:55296
    v_mfma_f32_16x16x32_bf16 v[60:63], v[148:151], v[244:247], v[60:63]
    ds_read_b128 v[220:223], v2 offset:56320
    v_mfma_f32_16x16x32_bf16 v[64:67], v[152:155], v[240:243], v[64:67]
    ds_read_b128 v[224:227], v2 offset:57344
    v_mfma_f32_16x16x32_bf16 v[68:71], v[152:155], v[244:247], v[68:71]
    ds_read_b128 v[228:231], v2 offset:58368
    v_mfma_f32_16x16x32_bf16 v[72:75], v[156:159], v[240:243], v[72:75]
    ds_read_b128 v[232:235], v2 offset:59392
    v_mfma_f32_16x16x32_bf16 v[76:79], v[156:159], v[244:247], v[76:79]
    ds_read_b128 v[236:239], v2 offset:60416
    v_mfma_f32_16x16x32_bf16 v[80:83], v[160:163], v[240:243], v[80:83]
    v_mfma_f32_16x16x32_bf16 v[84:87], v[160:163], v[244:247], v[84:87]
    s_add_u32 m0, s26, 61440
    v_mfma_f32_16x16x32_bf16 v[88:91], v[164:167], v[240:243], v[88:91]
    buffer_load_dwordx4 v1, s[8:11], s24 offen offset:0 lds
    v_mfma_f32_16x16x32_bf16 v[92:95], v[164:167], v[244:247], v[92:95]
    v_mfma_f32_16x16x32_bf16 v[96:99], v[168:171], v[240:243], v[96:99]
    buffer_load_dwordx4 v1, s[8:11], s24 offen offset:1024 lds
    v_mfma_f32_16x16x32_bf16 v[100:103], v[168:171], v[244:247], v[100:103]
    v_mfma_f32_16x16x32_bf16 v[104:107], v[172:175], v[240:243], v[104:107]
    buffer_load_dwordx4 v1, s[8:11], s24 offen offset:2048 lds
    v_mfma_f32_16x16x32_bf16 v[108:111], v[172:175], v[244:247], v[108:111]
    v_mfma_f32_16x16x32_bf16 v[112:115], v[176:179], v[240:243], v[112:115]
    buffer_load_dwordx4 v1, s[8:11], s24 offen offset:3072 lds
    s_add_u32 s24, s24, s25
    v_mfma_f32_16x16x32_bf16 v[116:119], v[176:179], v[244:247], v[116:119]
    v_mfma_f32_16x16x32_bf16 v[120:123], v[180:183], v[240:243], v[120:123]
    v_mfma_f32_16x16x32_bf16 v[124:127], v[180:183], v[244:247], v[124:127]
    s_waitcnt vmcnt(8) lgkmcnt(0)
    s_barrier
    v_mfma_f32_16x16x32_bf16 v[16:19], v[184:187], v[248:251], v[16:19]
    ds_read_b128 v[240:243], v3 offset:0
    v_mfma_f32_16x16x32_bf16 v[20:23], v[184:187], v[252:255], v[20:23]
    ds_read_b128 v[244:247], v3 offset:1024
    v_mfma_f32_16x16x32_bf16 v[24:27], v[188:191], v[248:251], v[24:27]
    ds_read_b128 v[128:131], v1 offset:16384
    v_mfma_f32_16x16x32_bf16 v[28:31], v[188:191], v[252:255], v[28:31]
    ds_read_b128 v[132:135], v1 offset:17408
    v_mfma_f32_16x16x32_bf16 v[32:35], v[192:195], v[248:251], v[32:35]
    ds_read_b128 v[136:139], v1 offset:18432
    v_mfma_f32_16x16x32_bf16 v[36:39], v[192:195], v[252:255], v[36:39]
    ds_read_b128 v[140:143], v1 offset:19456
    v_mfma_f32_16x16x32_bf16 v[40:43], v[196:199], v[248:251], v[40:43]
    ds_read_b128 v[144:147], v1 offset:20480
    v_mfma_f32_16x16x32_bf16 v[44:47], v[196:199], v[252:255], v[44:47]
    ds_read_b128 v[148:151], v1 offset:21504
    v_mfma_f32_16x16x32_bf16 v[48:51], v[200:203], v[248:251], v[48:51]
    ds_read_b128 v[152:155], v1 offset:22528
    v_mfma_f32_16x16x32_bf16 v[52:55], v[200:203], v[252:255], v[52:55]
    ds_read_b128 v[156:159], v1 offset:23552
    v_mfma_f32_16x16x32_bf16 v[56:59], v[204:207], v[248:251], v[56:59]
    ds_read_b128 v[160:163], v1 offset:24576
    v_mfma_f32_16x16x32_bf16 v[60:63], v[204:207], v[252:255], v[60:63]
    ds_read_b128 v[164:167], v1 offset:25600
    v_mfma_f32_16x16x32_bf16 v[64:67], v[208:211], v[248:251], v[64:67]
    ds_read_b128 v[168:171], v1 offset:26624
    v_mfma_f32_16x16x32_bf16 v[68:71], v[208:211], v[252:255], v[68:71]
    ds_read_b128 v[172:175], v1 offset:27648
    v_mfma_f32_16x16x32_bf16 v[72:75], v[212:215], v[248:251], v[72:75]
    ds_read_b128 v[176:179], v1 offset:28672
    v_mfma_f32_16x16x32_bf16 v[76:79], v[212:215], v[252:255], v[76:79]
    ds_read_b128 v[180:183], v1 offset:29696
    v_mfma_f32_16x16x32_bf16 v[80:83], v[216:219], v[248:251], v[80:83]
    v_mfma_f32_16x16x32_bf16 v[84:87], v[216:219], v[252:255], v[84:87]
    s_add_u32 m0, s26, 92160
    v_mfma_f32_16x16x32_bf16 v[88:91], v[220:223], v[248:251], v[88:91]
    buffer_load_dwordx4 v1, s[8:11], s24 offen offset:0 lds
    v_mfma_f32_16x16x32_bf16 v[92:95], v[220:223], v[252:255], v[92:95]
    v_mfma_f32_16x16x32_bf16 v[96:99], v[224:227], v[248:251], v[96:99]
    buffer_load_dwordx4 v1, s[8:11], s24 offen offset:1024 lds
    v_mfma_f32_16x16x32_bf16 v[100:103], v[224:227], v[252:255], v[100:103]
    v_mfma_f32_16x16x32_bf16 v[104:107], v[228:231], v[248:251], v[104:107]
    buffer_load_dwordx4 v1, s[8:11], s24 offen offset:2048 lds
    v_mfma_f32_16x16x32_bf16 v[108:111], v[228:231], v[252:255], v[108:111]
    v_mfma_f32_16x16x32_bf16 v[112:115], v[232:235], v[248:251], v[112:115]
    buffer_load_dwordx4 v1, s[8:11], s24 offen offset:3072 lds
    s_add_u32 s24, s24, s25
    v_mfma_f32_16x16x32_bf16 v[116:119], v[232:235], v[252:255], v[116:119]
    v_mfma_f32_16x16x32_bf16 v[120:123], v[236:239], v[248:251], v[120:123]
    v_mfma_f32_16x16x32_bf16 v[124:127], v[236:239], v[252:255], v[124:127]
    s_mov_b32 s30, 6
L_k4_loop:
    s_waitcnt vmcnt(8) lgkmcnt(0)
    s_barrier
    v_mfma_f32_16x16x32_bf16 v[16:19], v[128:131], v[240:243], v[16:19]
    ds_read_b128 v[248:251], v3 offset:30720
    v_mfma_f32_16x16x32_bf16 v[20:23], v[128:131], v[244:247], v[20:23]
    ds_read_b128 v[252:255], v3 offset:31744
    v_mfma_f32_16x16x32_bf16 v[24:27], v[132:135], v[240:243], v[24:27]
    ds_read_b128 v[184:187], v1 offset:47104
    v_mfma_f32_16x16x32_bf16 v[28:31], v[132:135], v[244:247], v[28:31]
    ds_read_b128 v[188:191], v1 offset:48128
    v_mfma_f32_16x16x32_bf16 v[32:35], v[136:139], v[240:243], v[32:35]
    ds_read_b128 v[192:195], v1 offset:49152
    v_mfma_f32_16x16x32_bf16 v[36:39], v[136:139], v[244:247], v[36:39]
    ds_read_b128 v[196:199], v1 offset:50176
    v_mfma_f32_16x16x32_bf16 v[40:43], v[140:143], v[240:243], v[40:43]
    ds_read_b128 v[200:203], v1 offset:51200
    v_mfma_f32_16x16x32_bf16 v[44:47], v[140:143], v[244:247], v[44:47]
    ds_read_b128 v[204:207], v1 offset:52224
    v_mfma_f32_16x16x32_bf16 v[48:51], v[144:147], v[240:243], v[48:51]
    ds_read_b128 v[208:211], v1 offset:53248
    v_mfma_f32_16x16x32_bf16 v[52:55], v[144:147], v[244:247], v[52:55]
    ds_read_b128 v[212:215], v1 offset:54272
    v_mfma_f32_16x16x32_bf16 v[56:59], v[148:151], v[240:243], v[56:59]
    ds_read_b128 v[216:219], v1 offset:55296
    v_mfma_f32_16x16x32_bf16 v[60:63], v[148:151], v[244:247], v[60:63]
    ds_read_b128 v[220:223], v1 offset:56320
    v_mfma_f32_16x16x32_bf16 v[64:67], v[152:155], v[240:243], v[64:67]
    ds_read_b128 v[224:227], v1 offset:57344
    v_mfma_f32_16x16x32_bf16 v[68:71], v[152:155], v[244:247], v[68:71]
    ds_read_b128 v[228:231], v1 offset:58368
    v_mfma_f32_16x16x32_bf16 v[72:75], v[156:159], v[240:243], v[72:75]
    ds_read_b128 v[232:235], v1 offset:59392
    v_mfma_f32_16x16x32_bf16 v[76:79], v[156:159], v[244:247], v[76:79]
    ds_read_b128 v[236:239], v1 offset:60416
    v_mfma_f32_16x16x32_bf16 v[80:83], v[160:163], v[240:243], v[80:83]
    v_mfma_f32_16x16x32_bf16 v[84:87], v[160:163], v[244:247], v[84:87]
    s_add_u32 m0, s26, 0
    v_mfma_f32_16x16x32_bf16 v[88:91], v[164:167], v[240:243], v[88:91]
    buffer_load_dwordx4 v1, s[8:11], s24 offen offset:0 lds
    v_mfma_f32_16x16x32_bf16 v[92:95], v[164:167], v[244:247], v[92:95]
    v_mfma_f32_16x16x32_bf16 v[96:99], v[168:171], v[240:243], v[96:99]
    buffer_load_dwordx4 v1, s[8:11], s24 offen offset:1024 lds
    v_mfma_f32_16x16x32_bf16 v[100:103], v[168:171], v[244:247], v[100:103]
    v_mfma_f32_16x16x32_bf16 v[104:107], v[172:175], v[240:243], v[104:107]
    buffer_load_dwordx4 v1, s[8:11], s24 offen offset:2048 lds
    v_mfma_f32_16x16x32_bf16 v[108:111], v[172:175], v[244:247], v[108:111]
    v_mfma_f32_16x16x32_bf16 v[112:115], v[176:179], v[240:243], v[112:115]
    buffer_load_dwordx4 v1, s[8:11], s24 offen offset:3072 lds
    s_add_u32 s24, s24, s25
    v_mfma_f32_16x16x32_bf16 v[116:119], v[176:179], v[244:247], v[116:119]
    v_mfma_f32_16x16x32_bf16 v[120:123], v[180:183], v[240:243], v[120:123]
    v_mfma_f32_16x16x32_bf16 v[124:127], v[180:183], v[244:247], v[124:127]
    s_waitcnt vmcnt(8) lgkmcnt(0)
    s_barrier
    v_mfma_f32_16x16x32_bf16 v[16:19], v[184:187], v[248:251], v[16:19]
    ds_read_b128 v[240:243], v4 offset:0
    v_mfma_f32_16x16x32_bf16 v[20:23], v[184:187], v[252:255], v[20:23]
    ds_read_b128 v[244:247], v4 offset:1024
    v_mfma_f32_16x16x32_bf16 v[24:27], v[188:191], v[248:251], v[24:27]
    ds_read_b128 v[128:131], v2 offset:16384
    v_mfma_f32_16x16x32_bf16 v[28:31], v[188:191], v[252:255], v[28:31]
    ds_read_b128 v[132:135], v2 offset:17408
    v_mfma_f32_16x16x32_bf16 v[32:35], v[192:195], v[248:251], v[32:35]
    ds_read_b128 v[136:139], v2 offset:18432
    v_mfma_f32_16x16x32_bf16 v[36:39], v[192:195], v[252:255], v[36:39]
    ds_read_b128 v[140:143], v2 offset:19456
    v_mfma_f32_16x16x32_bf16 v[40:43], v[196:199], v[248:251], v[40:43]
    ds_read_b128 v[144:147], v2 offset:20480
    v_mfma_f32_16x16x32_bf16 v[44:47], v[196:199], v[252:255], v[44:47]
    ds_read_b128 v[148:151], v2 offset:21504
    v_mfma_f32_16x16x32_bf16 v[48:51], v[200:203], v[248:251], v[48:51]
    ds_read_b128 v[152:155], v2 offset:22528
    v_mfma_f32_16x16x32_bf16 v[52:55], v[200:203], v[252:255], v[52:55]
    ds_read_b128 v[156:159], v2 offset:23552
    v_mfma_f32_16x16x32_bf16 v[56:59], v[204:207], v[248:251], v[56:59]
    ds_read_b128 v[160:163], v2 offset:24576
    v_mfma_f32_16x16x32_bf16 v[60:63], v[204:207], v[252:255], v[60:63]
    ds_read_b128 v[164:167], v2 offset:25600
    v_mfma_f32_16x16x32_bf16 v[64:67], v[208:211], v[248:251], v[64:67]
    ds_read_b128 v[168:171], v2 offset:26624
    v_mfma_f32_16x16x32_bf16 v[68:71], v[208:211], v[252:255], v[68:71]
    ds_read_b128 v[172:175], v2 offset:27648
    v_mfma_f32_16x16x32_bf16 v[72:75], v[212:215], v[248:251], v[72:75]
    ds_read_b128 v[176:179], v2 offset:28672
    v_mfma_f32_16x16x32_bf16 v[76:79], v[212:215], v[252:255], v[76:79]
    ds_read_b128 v[180:183], v2 offset:29696
    v_mfma_f32_16x16x32_bf16 v[80:83], v[216:219], v[248:251], v[80:83]
    v_mfma_f32_16x16x32_bf16 v[84:87], v[216:219], v[252:255], v[84:87]
    s_add_u32 m0, s26, 30720
    v_mfma_f32_16x16x32_bf16 v[88:91], v[220:223], v[248:251], v[88:91]
    buffer_load_dwordx4 v1, s[8:11], s24 offen offset:0 lds
    v_mfma_f32_16x16x32_bf16 v[92:95], v[220:223], v[252:255], v[92:95]
    v_mfma_f32_16x16x32_bf16 v[96:99], v[224:227], v[248:251], v[96:99]
    buffer_load_dwordx4 v1, s[8:11], s24 offen offset:1024 lds
    v_mfma_f32_16x16x32_bf16 v[100:103], v[224:227], v[252:255], v[100:103]
    v_mfma_f32_16x16x32_bf16 v[104:107], v[228:231], v[248:251], v[104:107]
    buffer_load_dwordx4 v1, s[8:11], s24 offen offset:2048 lds
    v_mfma_f32_16x16x32_bf16 v[108:111], v[228:231], v[252:255], v[108:111]
    v_mfma_f32_16x16x32_bf16 v[112:115], v[232:235], v[248:251], v[112:115]
    buffer_load_dwordx4 v1, s[8:11], s24 offen offset:3072 lds
    s_add_u32 s24, s24, s25
    v_mfma_f32_16x16x32_bf16 v[116:119], v[232:235], v[252:255], v[116:119]
    v_mfma_f32_16x16x32_bf16 v[120:123], v[236:239], v[248:251], v[120:123]
    v_mfma_f32_16x16x32_bf16 v[124:127], v[236:239], v[252:255], v[124:127]
    s_waitcnt vmcnt(8) lgkmcnt(0)
    s_barrier
    v_mfma_f32_16x16x32_bf16 v[16:19], v[128:131], v[240:243], v[16:19]
    ds_read_b128 v[248:251], v4 offset:30720
    v_mfma_f32_16x16x32_bf16 v[20:23], v[128:131], v[244:247], v[20:23]
    ds_read_b128 v[252:255], v4 offset:31744
    v_mfma_f32_16x16x32_bf16 v[24:27], v[132:135], v[240:243], v[24:27]
    ds_read_b128 v[184:187], v2 offset:47104
    v_mfma_f32_16x16x32_bf16 v[28:31], v[132:135], v[244:247], v[28:31]
    ds_read_b128 v[188:191], v2 offset:48128
    v_mfma_f32_16x16x32_bf16 v[32:35], v[136:139], v[240:243], v[32:35]
    ds_read_b128 v[192:195], v2 offset:49152
    v_mfma_f32_16x16x32_bf16 v[36:39], v[136:139], v[244:247], v[36:39]
    ds_read_b128 v[196:199], v2 offset:50176
    v_mfma_f32_16x16x32_bf16 v[40:43], v[140:143], v[240:243], v[40:43]
    ds_read_b128 v[200:203], v2 offset:51200
    v_mfma_f32_16x16x32_bf16 v[44:47], v[140:143], v[244:247], v[44:47]
    ds_read_b128 v[204:207], v2 offset:52224
    v_mfma_f32_16x16x32_bf16 v[48:51], v[144:147], v[240:243], v[48:51]
    ds_read_b128 v[208:211], v2 offset:53248
    v_mfma_f32_16x16x32_bf16 v[52:55], v[144:147], v[244:247], v[52:55]
    ds_read_b128 v[212:215], v2 offset:54272
    v_mfma_f32_16x16x32_bf16 v[56:59], v[148:151], v[240:243], v[56:59]
    ds_read_b128 v[216:219], v2 offset:55296
    v_mfma_f32_16x16x32_bf16 v[60:63], v[148:151], v[244:247], v[60:63]
    ds_read_b128 v[220:223], v2 offset:56320
    v_mfma_f32_16x16x32_bf16 v[64:67], v[152:155], v[240:243], v[64:67]
    ds_read_b128 v[224:227], v2 offset:57344
    v_mfma_f32_16x16x32_bf16 v[68:71], v[152:155], v[244:247], v[68:71]
    ds_read_b128 v[228:231], v2 offset:58368
    v_mfma_f32_16x16x32_bf16 v[72:75], v[156:159], v[240:243], v[72:75]
    ds_read_b128 v[232:235], v2 offset:59392
    v_mfma_f32_16x16x32_bf16 v[76:79], v[156:159], v[244:247], v[76:79]
    ds_read_b128 v[236:239], v2 offset:60416
    v_mfma_f32_16x16x32_bf16 v[80:83], v[160:163], v[240:243], v[80:83]
    v_mfma_f32_16x16x32_bf16 v[84:87], v[160:163], v[244:247], v[84:87]
    s_add_u32 m0, s26, 61440
    v_mfma_f32_16x16x32_bf16 v[88:91], v[164:167], v[240:243], v[88:91]
    buffer_load_dwordx4 v1, s[8:11], s24 offen offset:0 lds
    v_mfma_f32_16x16x32_bf16 v[92:95], v[164:167], v[244:247], v[92:95]
    v_mfma_f32_16x16x32_bf16 v[96:99], v[168:171], v[240:243], v[96:99]
    buffer_load_dwordx4 v1, s[8:11], s24 offen offset:1024 lds
    v_mfma_f32_16x16x32_bf16 v[100:103], v[168:171], v[244:247], v[100:103]
    v_mfma_f32_16x16x32_bf16 v[104:107], v[172:175], v[240:243], v[104:107]
    buffer_load_dwordx4 v1, s[8:11], s24 offen offset:2048 lds
    v_mfma_f32_16x16x32_bf16 v[108:111], v[172:175], v[244:247], v[108:111]
    v_mfma_f32_16x16x32_bf16 v[112:115], v[176:179], v[240:243], v[112:115]
    buffer_load_dwordx4 v1, s[8:11], s24 offen offset:3072 lds
    s_add_u32 s24, s24, s25
    v_mfma_f32_16x16x32_bf16 v[116:119], v[176:179], v[244:247], v[116:119]
    v_mfma_f32_16x16x32_bf16 v[120:123], v[180:183], v[240:243], v[120:123]
    v_mfma_f32_16x16x32_bf16 v[124:127], v[180:183], v[244:247], v[124:127]
    s_waitcnt vmcnt(8) lgkmcnt(0)
    s_barrier
    v_mfma_f32_16x16x32_bf16 v[16:19], v[184:187], v[248:251], v[16:19]
    ds_read_b128 v[240:243], v3 offset:0
    v_mfma_f32_16x16x32_bf16 v[20:23], v[184:187], v[252:255], v[20:23]
    ds_read_b128 v[244:247], v3 offset:1024
    v_mfma_f32_16x16x32_bf16 v[24:27], v[188:191], v[248:251], v[24:27]
    ds_read_b128 v[128:131], v1 offset:16384
    v_mfma_f32_16x16x32_bf16 v[28:31], v[188:191], v[252:255], v[28:31]
    ds_read_b128 v[132:135], v1 offset:17408
    v_mfma_f32_16x16x32_bf16 v[32:35], v[192:195], v[248:251], v[32:35]
    ds_read_b128 v[136:139], v1 offset:18432
    v_mfma_f32_16x16x32_bf16 v[36:39], v[192:195], v[252:255], v[36:39]
    ds_read_b128 v[140:143], v1 offset:19456
    v_mfma_f32_16x16x32_bf16 v[40:43], v[196:199], v[248:251], v[40:43]
    ds_read_b128 v[144:147], v1 offset:20480
    v_mfma_f32_16x16x32_bf16 v[44:47], v[196:199], v[252:255], v[44:47]
    ds_read_b128 v[148:151], v1 offset:21504
    v_mfma_f32_16x16x32_bf16 v[48:51], v[200:203], v[248:251], v[48:51]
    ds_read_b128 v[152:155], v1 offset:22528
    v_mfma_f32_16x16x32_bf16 v[52:55], v[200:203], v[252:255], v[52:55]
    ds_read_b128 v[156:159], v1 offset:23552
    v_mfma_f32_16x16x32_bf16 v[56:59], v[204:207], v[248:251], v[56:59]
    ds_read_b128 v[160:163], v1 offset:24576
    v_mfma_f32_16x16x32_bf16 v[60:63], v[204:207], v[252:255], v[60:63]
    ds_read_b128 v[164:167], v1 offset:25600
    v_mfma_f32_16x16x32_bf16 v[64:67], v[208:211], v[248:251], v[64:67]
    ds_read_b128 v[168:171], v1 offset:26624
    v_mfma_f32_16x16x32_bf16 v[68:71], v[208:211], v[252:255], v[68:71]
    ds_read_b128 v[172:175], v1 offset:27648
    v_mfma_f32_16x16x32_bf16 v[72:75], v[212:215], v[248:251], v[72:75]
    ds_read_b128 v[176:179], v1 offset:28672
    v_mfma_f32_16x16x32_bf16 v[76:79], v[212:215], v[252:255], v[76:79]
    ds_read_b128 v[180:183], v1 offset:29696
    v_mfma_f32_16x16x32_bf16 v[80:83], v[216:219], v[248:251], v[80:83]
    v_mfma_f32_16x16x32_bf16 v[84:87], v[216:219], v[252:255], v[84:87]
    s_add_u32 m0, s26, 92160
    v_mfma_f32_16x16x32_bf16 v[88:91], v[220:223], v[248:251], v[88:91]
    buffer_load_dwordx4 v1, s[8:11], s24 offen offset:0 lds
    v_mfma_f32_16x16x32_bf16 v[92:95], v[220:223], v[252:255], v[92:95]
    v_mfma_f32_16x16x32_bf16 v[96:99], v[224:227], v[248:251], v[96:99]
    buffer_load_dwordx4 v1, s[8:11], s24 offen offset:1024 lds
    v_mfma_f32_16x16x32_bf16 v[100:103], v[224:227], v[252:255], v[100:103]
    v_mfma_f32_16x16x32_bf16 v[104:107], v[228:231], v[248:251], v[104:107]
    buffer_load_dwordx4 v1, s[8:11], s24 offen offset:2048 lds
    v_mfma_f32_16x16x32_bf16 v[108:111], v[228:231], v[252:255], v[108:111]
    v_mfma_f32_16x16x32_bf16 v[112:115], v[232:235], v[248:251], v[112:115]
    buffer_load_dwordx4 v1, s[8:11], s24 offen offset:3072 lds
    s_add_u32 s24, s24, s25
    v_mfma_f32_16x16x32_bf16 v[116:119], v[232:235], v[252:255], v[116:119]
    v_mfma_f32_16x16x32_bf16 v[120:123], v[236:239], v[248:251], v[120:123]
    v_mfma_f32_16x16x32_bf16 v[124:127], v[236:239], v[252:255], v[124:127]
    s_sub_u32 s30, s30, 1
    s_cmp_lg_u32 s30, 0
    s_cbranch_scc1 L_k4_loop
    s_waitcnt vmcnt(8) lgkmcnt(0)
    s_barrier
    v_mfma_f32_16x16x32_bf16 v[16:19], v[128:131], v[240:243], v[16:19]
    ds_read_b128 v[248:251], v3 offset:30720
    v_mfma_f32_16x16x32_bf16 v[20:23], v[128:131], v[244:247], v[20:23]
    ds_read_b128 v[252:255], v3 offset:31744
    v_mfma_f32_16x16x32_bf16 v[24:27], v[132:135], v[240:243], v[24:27]
    ds_read_b128 v[184:187], v1 offset:47104
    s_add_u32 m0, s51, 0
    v_mfma_f32_16x16x32_bf16 v[28:31], v[132:135], v[244:247], v[28:31]
    ds_read_b128 v[188:191], v1 offset:48128
    buffer_load_dwordx4 v5, s[8:11], s50 offen lds
    s_add_u32 s50, s50, 16384
    v_mfma_f32_16x16x32_bf16 v[32:35], v[136:139], v[240:243], v[32:35]
    ds_read_b128 v[192:195], v1 offset:49152
    s_add_u32 m0, s51, 1024
    v_mfma_f32_16x16x32_bf16 v[36:39], v[136:139], v[244:247], v[36:39]
    ds_read_b128 v[196:199], v1 offset:50176
    buffer_load_dwordx4 v5, s[8:11], s50 offen lds
    s_add_u32 s50, s50, 16384
    v_mfma_f32_16x16x32_bf16 v[40:43], v[140:143], v[240:243], v[40:43]
    ds_read_b128 v[200:203], v1 offset:51200
    s_add_u32 m0, s51, 2048
    v_mfma_f32_16x16x32_bf16 v[44:47], v[140:143], v[244:247], v[44:47]
    ds_read_b128 v[204:207], v1 offset:52224
    buffer_load_dwordx4 v5, s[8:11], s50 offen lds
    s_add_u32 s50, s50, 16384
    v_mfma_f32_16x16x32_bf16 v[48:51], v[144:147], v[240:243], v[48:51]
    ds_read_b128 v[208:211], v1 offset:53248
    s_add_u32 m0, s51, 3072
    v_mfma_f32_16x16x32_bf16 v[52:55], v[144:147], v[244:247], v[52:55]
    ds_read_b128 v[212:215], v1 offset:54272
    buffer_load_dwordx4 v5, s[8:11], s50 offen lds
    v_mfma_f32_16x16x32_bf16 v[56:59], v[148:151], v[240:243], v[56:59]
    ds_read_b128 v[216:219], v1 offset:55296
    s_mov_b32 m0, s53
    v_mfma_f32_16x16x32_bf16 v[60:63], v[148:151], v[244:247], v[60:63]
    ds_read_b128 v[220:223], v1 offset:56320
    buffer_load_dwordx4 v1, s[8:11], s52 offen lds
    v_mfma_f32_16x16x32_bf16 v[64:67], v[152:155], v[240:243], v[64:67]
    ds_read_b128 v[224:227], v1 offset:57344
    v_mfma_f32_16x16x32_bf16 v[68:71], v[152:155], v[244:247], v[68:71]
    ds_read_b128 v[228:231], v1 offset:58368
    v_mfma_f32_16x16x32_bf16 v[72:75], v[156:159], v[240:243], v[72:75]
    ds_read_b128 v[232:235], v1 offset:59392
    v_mfma_f32_16x16x32_bf16 v[76:79], v[156:159], v[244:247], v[76:79]
    ds_read_b128 v[236:239], v1 offset:60416
    v_mfma_f32_16x16x32_bf16 v[80:83], v[160:163], v[240:243], v[80:83]
    v_mfma_f32_16x16x32_bf16 v[84:87], v[160:163], v[244:247], v[84:87]
    v_mfma_f32_16x16x32_bf16 v[88:91], v[164:167], v[240:243], v[88:91]
    v_mfma_f32_16x16x32_bf16 v[92:95], v[164:167], v[244:247], v[92:95]
    v_mfma_f32_16x16x32_bf16 v[96:99], v[168:171], v[240:243], v[96:99]
    v_mfma_f32_16x16x32_bf16 v[100:103], v[168:171], v[244:247], v[100:103]
    v_mfma_f32_16x16x32_bf16 v[104:107], v[172:175], v[240:243], v[104:107]
    v_mfma_f32_16x16x32_bf16 v[108:111], v[172:175], v[244:247], v[108:111]
    v_mfma_f32_16x16x32_bf16 v[112:115], v[176:179], v[240:243], v[112:115]
    v_mfma_f32_16x16x32_bf16 v[116:119], v[176:179], v[244:247], v[116:119]
    v_mfma_f32_16x16x32_bf16 v[120:123], v[180:183], v[240:243], v[120:123]
    v_mfma_f32_16x16x32_bf16 v[124:127], v[180:183], v[244:247], v[124:127]
    s_waitcnt vmcnt(9) lgkmcnt(0)
    s_barrier
    v_mfma_f32_16x16x32_bf16 v[16:19], v[184:187], v[248:251], v[16:19]
    ds_read_b128 v[240:243], v4 offset:0
    v_mfma_f32_16x16x32_bf16 v[20:23], v[184:187], v[252:255], v[20:23]
    ds_read_b128 v[244:247], v4 offset:1024
    v_mfma_f32_16x16x32_bf16 v[24:27], v[188:191], v[248:251], v[24:27]
    ds_read_b128 v[128:131], v2 offset:16384
    v_mfma_f32_16x16x32_bf16 v[28:31], v[188:191], v[252:255], v[28:31]
    ds_read_b128 v[132:135], v2 offset:17408
    v_mfma_f32_16x16x32_bf16 v[32:35], v[192:195], v[248:251], v[32:35]
    ds_read_b128 v[136:139], v2 offset:18432
    v_mfma_f32_16x16x32_bf16 v[36:39], v[192:195], v[252:255], v[36:39]
    ds_read_b128 v[140:143], v2 offset:19456
    v_mfma_f32_16x16x32_bf16 v[40:43], v[196:199], v[248:251], v[40:43]
    ds_read_b128 v[144:147], v2 offset:20480
    v_mfma_f32_16x16x32_bf16 v[44:47], v[196:199], v[252:255], v[44:47]
    ds_read_b128 v[148:151], v2 offset:21504
    v_mfma_f32_16x16x32_bf16 v[48:51], v[200:203], v[248:251], v[48:51]
    ds_read_b128 v[152:155], v2 offset:22528
    v_mfma_f32_16x16x32_bf16 v[52:55], v[200:203], v[252:255], v[52:55]
    ds_read_b128 v[156:159], v2 offset:23552
    v_mfma_f32_16x16x32_bf16 v[56:59], v[204:207], v[248:251], v[56:59]
    ds_read_b128 v[160:163], v2 offset:24576
    v_mfma_f32_16x16x32_bf16 v[60:63], v[204:207], v[252:255], v[60:63]
    ds_read_b128 v[164:167], v2 offset:25600
    v_mfma_f32_16x16x32_bf16 v[64:67], v[208:211], v[248:251], v[64:67]
    ds_read_b128 v[168:171], v2 offset:26624
    v_mfma_f32_16x16x32_bf16 v[68:71], v[208:211], v[252:255], v[68:71]
    ds_read_b128 v[172:175], v2 offset:27648
    v_mfma_f32_16x16x32_bf16 v[72:75], v[212:215], v[248:251], v[72:75]
    ds_read_b128 v[176:179], v2 offset:28672
    v_mfma_f32_16x16x32_bf16 v[76:79], v[212:215], v[252:255], v[76:79]
    ds_read_b128 v[180:183], v2 offset:29696
    v_mfma_f32_16x16x32_bf16 v[80:83], v[216:219], v[248:251], v[80:83]
    v_mfma_f32_16x16x32_bf16 v[84:87], v[216:219], v[252:255], v[84:87]
    v_mfma_f32_16x16x32_bf16 v[88:91], v[220:223], v[248:251], v[88:91]
    v_mfma_f32_16x16x32_bf16 v[92:95], v[220:223], v[252:255], v[92:95]
    v_mfma_f32_16x16x32_bf16 v[96:99], v[224:227], v[248:251], v[96:99]
    v_mfma_f32_16x16x32_bf16 v[100:103], v[224:227], v[252:255], v[100:103]
    v_mfma_f32_16x16x32_bf16 v[104:107], v[228:231], v[248:251], v[104:107]
    v_mfma_f32_16x16x32_bf16 v[108:111], v[228:231], v[252:255], v[108:111]
    v_mfma_f32_16x16x32_bf16 v[112:115], v[232:235], v[248:251], v[112:115]
    v_mfma_f32_16x16x32_bf16 v[116:119], v[232:235], v[252:255], v[116:119]
    v_mfma_f32_16x16x32_bf16 v[120:123], v[236:239], v[248:251], v[120:123]
    v_mfma_f32_16x16x32_bf16 v[124:127], v[236:239], v[252:255], v[124:127]
    s_waitcnt vmcnt(0) lgkmcnt(0)
    s_barrier
    v_mfma_f32_16x16x32_bf16 v[16:19], v[128:131], v[240:243], v[16:19]
    ds_read_b128 v[248:251], v4 offset:30720
    v_mfma_f32_16x16x32_bf16 v[20:23], v[128:131], v[244:247], v[20:23]
    ds_read_b128 v[252:255], v4 offset:31744
    v_mfma_f32_16x16x32_bf16 v[24:27], v[132:135], v[240:243], v[24:27]
    ds_read_b128 v[184:187], v2 offset:47104
    v_mfma_f32_16x16x32_bf16 v[28:31], v[132:135], v[244:247], v[28:31]
    ds_read_b128 v[188:191], v2 offset:48128
    v_mfma_f32_16x16x32_bf16 v[32:35], v[136:139], v[240:243], v[32:35]
    ds_read_b128 v[192:195], v2 offset:49152
    v_mfma_f32_16x16x32_bf16 v[36:39], v[136:139], v[244:247], v[36:39]
    ds_read_b128 v[196:199], v2 offset:50176
    v_mfma_f32_16x16x32_bf16 v[40:43], v[140:143], v[240:243], v[40:43]
    ds_read_b128 v[200:203], v2 offset:51200
    v_mfma_f32_16x16x32_bf16 v[44:47], v[140:143], v[244:247], v[44:47]
    ds_read_b128 v[204:207], v2 offset:52224
    v_mfma_f32_16x16x32_bf16 v[48:51], v[144:147], v[240:243], v[48:51]
    ds_read_b128 v[208:211], v2 offset:53248
    v_mfma_f32_16x16x32_bf16 v[52:55], v[144:147], v[244:247], v[52:55]
    ds_read_b128 v[212:215], v2 offset:54272
    v_mfma_f32_16x16x32_bf16 v[56:59], v[148:151], v[240:243], v[56:59]
    ds_read_b128 v[216:219], v2 offset:55296
    v_mfma_f32_16x16x32_bf16 v[60:63], v[148:151], v[244:247], v[60:63]
    ds_read_b128 v[220:223], v2 offset:56320
    v_mfma_f32_16x16x32_bf16 v[64:67], v[152:155], v[240:243], v[64:67]
    ds_read_b128 v[224:227], v2 offset:57344
    v_mfma_f32_16x16x32_bf16 v[68:71], v[152:155], v[244:247], v[68:71]
    ds_read_b128 v[228:231], v2 offset:58368
    v_mfma_f32_16x16x32_bf16 v[72:75], v[156:159], v[240:243], v[72:75]
    ds_read_b128 v[232:235], v2 offset:59392
    v_min_u32 v14, 2, v0
    v_mfma_f32_16x16x32_bf16 v[76:79], v[156:159], v[244:247], v[76:79]
    ds_read_b128 v[236:239], v2 offset:60416
    s_lshr_b32 s62, s2, 3
    v_mfma_f32_16x16x32_bf16 v[80:83], v[160:163], v[240:243], v[80:83]
    s_mul_i32 s62, s62, 384
    v_mfma_f32_16x16x32_bf16 v[84:87], v[160:163], v[244:247], v[84:87]
    v_lshl_add_u32 v14, v14, 7, s62
    v_mfma_f32_16x16x32_bf16 v[88:91], v[164:167], v[240:243], v[88:91]
    v_min_u32 v14, TEXT_END-K4_EPI-4, v14
    v_mfma_f32_16x16x32_bf16 v[92:95], v[164:167], v[244:247], v[92:95]
    s_getpc_b64 s[62:63]
CPF12:
    s_add_u32 s62, s62, K4_EPI-CPF12
    v_mfma_f32_16x16x32_bf16 v[96:99], v[168:171], v[240:243], v[96:99]
    s_addc_u32 s63, s63, 0
    v_mfma_f32_16x16x32_bf16 v[100:103], v[168:171], v[244:247], v[100:103]
    v_mov_b32 v15, s63
    v_mfma_f32_16x16x32_bf16 v[104:107], v[172:175], v[240:243], v[104:107]
    v_add_co_u32 v14, vcc, s62, v14
    v_mfma_f32_16x16x32_bf16 v[108:111], v[172:175], v[244:247], v[108:111]
    s_nop 0
    v_addc_co_u32 v15, vcc, 0, v15, vcc
    v_mfma_f32_16x16x32_bf16 v[112:115], v[176:179], v[240:243], v[112:115]
    global_load_dword v5, v[14:15], off
    v_mfma_f32_16x16x32_bf16 v[116:119], v[176:179], v[244:247], v[116:119]
    v_mfma_f32_16x16x32_bf16 v[120:123], v[180:183], v[240:243], v[120:123]
    v_mfma_f32_16x16x32_bf16 v[124:127], v[180:183], v[244:247], v[124:127]
    s_waitcnt lgkmcnt(0)
    v_mfma_f32_16x16x32_bf16 v[16:19], v[184:187], v[248:251], v[16:19]
    v_add_u32 v14, s51, v1
    ds_read_b128 v[128:131], v14 offset:0
    ds_read_b128 v[132:135], v14 offset:1024
    ds_read_b128 v[136:139], v14 offset:2048
    ds_read_b128 v[140:143], v14 offset:3072
    v_mfma_f32_16x16x32_bf16 v[20:23], v[184:187], v[252:255], v[20:23]
    ds_read_b128 v[144:147], v1 offset:0
    ds_read_b128 v[148:151], v1 offset:1024
    v_mfma_f32_16x16x32_bf16 v[24:27], v[188:191], v[248:251], v[24:27]
    ds_read_b128 v[152:155], v1 offset:2048
    ds_read_b128 v[156:159], v1 offset:3072
    v_mfma_f32_16x16x32_bf16 v[28:31], v[188:191], v[252:255], v[28:31]
    ds_read_b128 v[160:163], v1 offset:4096
    ds_read_b128 v[164:167], v1 offset:5120
    v_mfma_f32_16x16x32_bf16 v[32:35], v[192:195], v[248:251], v[32:35]
    ds_read_b128 v[168:171], v1 offset:6144
    ds_read_b128 v[172:175], v1 offset:7168
    v_mfma_f32_16x16x32_bf16 v[36:39], v[192:195], v[252:255], v[36:39]
    s_waitcnt lgkmcnt(0)
    v_pk_add_f32 v[144:145], v[144:145], v[160:161]
    v_pk_add_f32 v[146:147], v[146:147], v[162:163]
    v_pk_add_f32 v[148:149], v[148:149], v[164:165]
    v_pk_add_f32 v[150:151], v[150:151], v[166:167]
    v_mfma_f32_16x16x32_bf16 v[40:43], v[196:199], v[248:251], v[40:43]
    v_pk_add_f32 v[152:153], v[152:153], v[168:169]
    v_pk_add_f32 v[154:155], v[154:155], v[170:171]
    v_pk_add_f32 v[156:157], v[156:157], v[172:173]
    v_mfma_f32_16x16x32_bf16 v[44:47], v[196:199], v[252:255], v[44:47]
    v_pk_add_f32 v[158:159], v[158:159], v[174:175]
    v_pk_add_f32 v[144:145], v[144:145], v[152:153]
    v_pk_add_f32 v[146:147], v[146:147], v[154:155]
    v_pk_add_f32 v[148:149], v[148:149], v[156:157]
    v_mfma_f32_16x16x32_bf16 v[48:51], v[200:203], v[248:251], v[48:51]
    v_pk_add_f32 v[150:151], v[150:151], v[158:159]
    v_pk_add_f32 v[144:145], v[144:145], v[148:149]
    v_pk_add_f32 v[146:147], v[146:147], v[150:151]
    v_mfma_f32_16x16x32_bf16 v[52:55], v[200:203], v[252:255], v[52:55]
    v_add_u32 v14, 122880, v1
    ds_write_b128 v14, v[144:147]
    v_pk_add_f32 v[160:161], v[128:129], v[132:133]
    v_pk_add_f32 v[172:173], v[130:131], v[134:135]
    v_mfma_f32_16x16x32_bf16 v[56:59], v[204:207], v[248:251], v[56:59]
    v_pk_add_f32 v[162:163], v[136:137], v[140:141]
    v_pk_add_f32 v[174:175], v[138:139], v[142:143]
    v_pk_add_f32 v[160:161], v[160:161], v[162:163]
    v_mfma_f32_16x16x32_bf16 v[60:63], v[204:207], v[252:255], v[60:63]
    v_pk_add_f32 v[172:173], v[172:173], v[174:175]
    v_mov_b32 v162, v160
    v_mov_b32 v174, v172
    s_nop 0
    v_permlane16_swap_b32 v160, v162
    v_mfma_f32_16x16x32_bf16 v[64:67], v[208:211], v[248:251], v[64:67]
    v_permlane16_swap_b32 v172, v174
    v_add_f32 v160, v160, v162
    v_add_f32 v172, v172, v174
    v_mfma_f32_16x16x32_bf16 v[68:71], v[208:211], v[252:255], v[68:71]
    v_mov_b32 v162, v160
    v_mov_b32 v174, v172
    s_nop 0
    v_permlane32_swap_b32 v160, v162
    v_permlane32_swap_b32 v172, v174
    v_mfma_f32_16x16x32_bf16 v[72:75], v[212:215], v[248:251], v[72:75]
    v_add_f32 v160, v160, v162
    v_add_f32 v172, v172, v174
    v_mul_f32 v6, 0xba800000, v160
    v_mfma_f32_16x16x32_bf16 v[76:79], v[212:215], v[252:255], v[76:79]
    v_mul_f32 v10, 0xba800000, v172
    v_fma_f32 v164, v128, s61, v6
    v_fma_f32 v176, v130, s61, v10
    v_fma_f32 v165, v132, s61, v6
    v_mfma_f32_16x16x32_bf16 v[80:83], v[216:219], v[248:251], v[80:83]
    v_fma_f32 v177, v134, s61, v10
    v_fma_f32 v166, v136, s61, v6
    v_fma_f32 v178, v138, s61, v10
    v_mfma_f32_16x16x32_bf16 v[84:87], v[216:219], v[252:255], v[84:87]
    v_fma_f32 v167, v140, s61, v6
    v_fma_f32 v179, v142, s61, v10
    v_mul_f32 v163, v164, v164
    v_mul_f32 v175, v176, v176
    v_mfma_f32_16x16x32_bf16 v[88:91], v[220:223], v[248:251], v[88:91]
    v_fmac_f32 v163, v165, v165
    v_fmac_f32 v175, v177, v177
    v_fmac_f32 v163, v166, v166
    v_mfma_f32_16x16x32_bf16 v[92:95], v[220:223], v[252:255], v[92:95]
    v_fmac_f32 v175, v178, v178
    v_fmac_f32 v163, v167, v167
    v_fmac_f32 v175, v179, v179
    v_fmac_f32 v161, 0x42800000, v163
    v_mfma_f32_16x16x32_bf16 v[96:99], v[224:227], v[248:251], v[96:99]
    v_fmac_f32 v173, 0x42800000, v175
    v_mov_b32 v162, v161
    v_mov_b32 v174, v173
    v_mfma_f32_16x16x32_bf16 v[100:103], v[224:227], v[252:255], v[100:103]
    v_permlane16_swap_b32 v161, v162
    v_permlane16_swap_b32 v173, v174
    v_add_f32 v161, v161, v162
    v_add_f32 v173, v173, v174
    v_mfma_f32_16x16x32_bf16 v[104:107], v[228:231], v[248:251], v[104:107]
    v_mov_b32 v162, v161
    v_mov_b32 v174, v173
    s_nop 0
    v_permlane32_swap_b32 v161, v162
    v_mfma_f32_16x16x32_bf16 v[108:111], v[228:231], v[252:255], v[108:111]
    v_permlane32_swap_b32 v173, v174
    v_add_f32 v161, v161, v162
    v_add_f32 v173, v173, v174
    v_mov_b32 v9, 0x3727c5ac
    v_mfma_f32_16x16x32_bf16 v[112:115], v[232:235], v[248:251], v[112:115]
    v_mov_b32 v13, 0x3727c5ac
    v_fmac_f32 v9, 0x3a800000, v161
    v_fmac_f32 v13, 0x3a800000, v173
    v_mfma_f32_16x16x32_bf16 v[116:119], v[232:235], v[252:255], v[116:119]
    v_rsq_f32 v163, v9
    v_rsq_f32 v175, v13
    v_mul_f32 v7, 0xc0135761, v163
    v_mul_f32 v11, 0xc0135761, v175
    v_mfma_f32_16x16x32_bf16 v[120:123], v[236:239], v[248:251], v[120:123]
    v_mul_f32 v164, v163, v163
    v_mul_f32 v176, v175, v175
    v_mul_f32 v164, v164, v7
    v_mfma_f32_16x16x32_bf16 v[124:127], v[236:239], v[252:255], v[124:127]
    v_mul_f32 v176, v176, v11
    v_mul_f32 v8, 0x3d372713, v164
    v_mul_f32 v12, 0x3d372713, v176
K4_EPI:
    v_lshlrev_b32 v14, 7, v0
    s_lshr_b32 s32, s17, 2
    s_and_b32 s33, s16, 1
    s_lshl_b32 s32, s32, 1
    s_add_u32 s32, s32, s33
    s_mul_i32 s32, s32, 56
    s_and_b32 s33, s17, 3
    s_add_u32 s32, s32, s33
    s_lshl_b32 s33, s3, 2
    s_add_u32 s32, s32, s33
    s_lshl_b32 s32, s32, 13
    s_add_u32 s32, s32, 50331648
    s_cmp_ge_u32 s3, 1
    s_cbranch_scc1 K4_NOPF
    buffer_load_dword v15, v14, s[8:11], s32 offen
K4_NOPF:
    v_lshrrev_b32 v14, 4, v0
    v_lshlrev_b32 v14, 4, v14
    v_add_u32 v14, 122880, v14
    ds_read_b128 v[128:131], v14 offset:0
    ds_read_b128 v[132:135], v14 offset:64
    ds_read_b128 v[136:139], v14 offset:128
    ds_read_b128 v[140:143], v14 offset:192
    ds_read_b128 v[144:147], v14 offset:256
    ds_read_b128 v[148:151], v14 offset:320
    ds_read_b128 v[152:155], v14 offset:384
    ds_read_b128 v[156:159], v14 offset:448
    ds_read_b128 v[160:163], v14 offset:512
    ds_read_b128 v[164:167], v14 offset:576
    ds_read_b128 v[168:171], v14 offset:640
    ds_read_b128 v[172:175], v14 offset:704
    ds_read_b128 v[176:179], v14 offset:768
    ds_read_b128 v[180:183], v14 offset:832
    s_lshr_b32 s32, s19, 1
    s_mul_i32 s32, s32, 7
    s_and_b32 s33, s19, 1
    s_lshl_b32 s34, s33, 2
    s_add_u32 s34, s34, s32
    s_add_u32 s32, s32, 3
    s_lshl_b32 s35, s18, 4
    s_lshl_b32 s36, s3, 1
    s_add_u32 s35, s35, s36
    s_lshl_b32 s34, s34, 7
    s_add_u32 s34, s34, s35
    s_lshl_b32 s34, s34, 10
    s_add_u32 s34, s34, 4194304
    s_lshl_b32 s32, s32, 7
    s_add_u32 s32, s32, s35
    s_lshl_b32 s32, s32, 10
    s_lshl_b32 s33, s33, 3
    s_add_u32 s32, s32, s33
    s_add_u32 s32, s32, 4194304
    s_waitcnt lgkmcnt(0)
    v_pk_fma_f32 v[216:217], v[128:129], v[6:7], v[16:17] op_sel_hi:[1,0,1]
    v_pk_fma_f32 v[222:223], v[128:129], v[10:11], v[20:21] op_sel_hi:[1,0,1]
    v_pk_fma_f32 v[228:229], v[130:131], v[6:7], v[18:19] op_sel_hi:[1,0,1]
    v_pk_fma_f32 v[234:235], v[130:131], v[10:11], v[22:23] op_sel_hi:[1,0,1]
    v_pk_fma_f32 v[218:219], v[132:133], v[6:7], v[24:25] op_sel_hi:[1,0,1]
    v_pk_fma_f32 v[224:225], v[132:133], v[10:11], v[28:29] op_sel_hi:[1,0,1]
    v_pk_fma_f32 v[230:231], v[134:135], v[6:7], v[26:27] op_sel_hi:[1,0,1]
    v_pk_fma_f32 v[236:237], v[134:135], v[10:11], v[30:31] op_sel_hi:[1,0,1]
    v_pk_mul_f32 v[220:221], v[216:217], v[216:217]
    v_pk_mul_f32 v[226:227], v[222:223], v[222:223]
    v_pk_mul_f32 v[232:233], v[228:229], v[228:229]
    v_pk_mul_f32 v[238:239], v[234:235], v[234:235]
    v_pk_fma_f32 v[220:221], v[220:221], v[8:9], v[6:7] op_sel:[0,0,1] op_sel_hi:[1,0,1]
    v_pk_fma_f32 v[226:227], v[226:227], v[12:13], v[10:11] op_sel:[0,0,1] op_sel_hi:[1,0,1]
    v_pk_fma_f32 v[232:233], v[232:233], v[8:9], v[6:7] op_sel:[0,0,1] op_sel_hi:[1,0,1]
    v_pk_fma_f32 v[238:239], v[238:239], v[12:13], v[10:11] op_sel:[0,0,1] op_sel_hi:[1,0,1]
    v_pk_mul_f32 v[220:221], v[220:221], v[216:217]
    v_pk_mul_f32 v[226:227], v[226:227], v[222:223]
    v_pk_mul_f32 v[232:233], v[232:233], v[228:229]
    v_pk_mul_f32 v[238:239], v[238:239], v[234:235]
    v_exp_f32 v220, v220
    v_exp_f32 v226, v226
    v_exp_f32 v232, v232
    v_exp_f32 v238, v238
    v_exp_f32 v221, v221
    v_exp_f32 v227, v227
    v_exp_f32 v233, v233
    v_exp_f32 v239, v239
    v_pk_mul_f32 v[216:217], v[216:217], v[218:219]
    v_pk_mul_f32 v[222:223], v[222:223], v[224:225]
    v_pk_mul_f32 v[228:229], v[228:229], v[230:231]
    v_pk_mul_f32 v[234:235], v[234:235], v[236:237]
    v_pk_fma_f32 v[220:221], v[220:221], v[8:9], v[8:9] op_sel:[0,1,1] op_sel_hi:[1,1,1]
    v_pk_fma_f32 v[226:227], v[226:227], v[12:13], v[12:13] op_sel:[0,1,1] op_sel_hi:[1,1,1]
    v_pk_fma_f32 v[232:233], v[232:233], v[8:9], v[8:9] op_sel:[0,1,1] op_sel_hi:[1,1,1]
    v_pk_fma_f32 v[238:239], v[238:239], v[12:13], v[12:13] op_sel:[0,1,1] op_sel_hi:[1,1,1]
    v_rcp_f32 v220, v220
    v_rcp_f32 v226, v226
    v_rcp_f32 v232, v232
    v_rcp_f32 v238, v238
    v_rcp_f32 v221, v221
    v_rcp_f32 v227, v227
    v_rcp_f32 v233, v233
    v_rcp_f32 v239, v239
    v_pk_mul_f32 v[216:217], v[216:217], v[220:221]
    v_pk_mul_f32 v[222:223], v[222:223], v[226:227]
    v_pk_mul_f32 v[228:229], v[228:229], v[232:233]
    v_pk_mul_f32 v[234:235], v[234:235], v[238:239]
    v_cvt_pk_bf16_f32 v184, v216, v217
    v_cvt_pk_bf16_f32 v200, v222, v223
    v_cvt_pk_bf16_f32 v185, v228, v229
    v_cvt_pk_bf16_f32 v201, v234, v235
    v_pk_fma_f32 v[216:217], v[136:137], v[6:7], v[32:33] op_sel_hi:[1,0,1]
    v_pk_fma_f32 v[222:223], v[136:137], v[10:11], v[36:37] op_sel_hi:[1,0,1]
    v_pk_fma_f32 v[228:229], v[138:139], v[6:7], v[34:35] op_sel_hi:[1,0,1]
    v_pk_fma_f32 v[234:235], v[138:139], v[10:11], v[38:39] op_sel_hi:[1,0,1]
    v_pk_fma_f32 v[218:219], v[140:141], v[6:7], v[40:41] op_sel_hi:[1,0,1]
    v_pk_fma_f32 v[224:225], v[140:141], v[10:11], v[44:45] op_sel_hi:[1,0,1]
    v_pk_fma_f32 v[230:231], v[142:143], v[6:7], v[42:43] op_sel_hi:[1,0,1]
    v_pk_fma_f32 v[236:237], v[142:143], v[10:11], v[46:47] op_sel_hi:[1,0,1]
    v_pk_mul_f32 v[220:221], v[216:217], v[216:217]
    v_pk_mul_f32 v[226:227], v[222:223], v[222:223]
    v_pk_mul_f32 v[232:233], v[228:229], v[228:229]
    v_pk_mul_f32 v[238:239], v[234:235], v[234:235]
    v_pk_fma_f32 v[220:221], v[220:221], v[8:9], v[6:7] op_sel:[0,0,1] op_sel_hi:[1,0,1]
    v_pk_fma_f32 v[226:227], v[226:227], v[12:13], v[10:11] op_sel:[0,0,1] op_sel_hi:[1,0,1]
    v_pk_fma_f32 v[232:233], v[232:233], v[8:9], v[6:7] op_sel:[0,0,1] op_sel_hi:[1,0,1]
    v_pk_fma_f32 v[238:239], v[238:239], v[12:13], v[10:11] op_sel:[0,0,1] op_sel_hi:[1,0,1]
    v_pk_mul_f32 v[220:221], v[220:221], v[216:217]
    v_pk_mul_f32 v[226:227], v[226:227], v[222:223]
    v_pk_mul_f32 v[232:233], v[232:233], v[228:229]
    v_pk_mul_f32 v[238:239], v[238:239], v[234:235]
    v_exp_f32 v220, v220
    v_exp_f32 v226, v226
    v_exp_f32 v232, v232
    v_exp_f32 v238, v238
    v_exp_f32 v221, v221
    v_exp_f32 v227, v227
    v_exp_f32 v233, v233
    v_exp_f32 v239, v239
    v_pk_mul_f32 v[216:217], v[216:217], v[218:219]
    v_pk_mul_f32 v[222:223], v[222:223], v[224:225]
    v_pk_mul_f32 v[228:229], v[228:229], v[230:231]
    v_pk_mul_f32 v[234:235], v[234:235], v[236:237]
    v_pk_fma_f32 v[220:221], v[220:221], v[8:9], v[8:9] op_sel:[0,1,1] op_sel_hi:[1,1,1]
    v_pk_fma_f32 v[226:227], v[226:227], v[12:13], v[12:13] op_sel:[0,1,1] op_sel_hi:[1,1,1]
    v_pk_fma_f32 v[232:233], v[232:233], v[8:9], v[8:9] op_sel:[0,1,1] op_sel_hi:[1,1,1]
    v_pk_fma_f32 v[238:239], v[238:239], v[12:13], v[12:13] op_sel:[0,1,1] op_sel_hi:[1,1,1]
    v_rcp_f32 v220, v220
    v_rcp_f32 v226, v226
    v_rcp_f32 v232, v232
    v_rcp_f32 v238, v238
    v_rcp_f32 v221, v221
    v_rcp_f32 v227, v227
    v_rcp_f32 v233, v233
    v_rcp_f32 v239, v239
    v_pk_mul_f32 v[216:217], v[216:217], v[220:221]
    v_pk_mul_f32 v[222:223], v[222:223], v[226:227]
    v_pk_mul_f32 v[228:229], v[228:229], v[232:233]
    v_pk_mul_f32 v[234:235], v[234:235], v[238:239]
    v_cvt_pk_bf16_f32 v186, v216, v217
    v_cvt_pk_bf16_f32 v202, v222, v223
    v_cvt_pk_bf16_f32 v187, v228, v229
    v_cvt_pk_bf16_f32 v203, v234, v235
    buffer_store_dwordx4 v[184:187], v1, s[8:11], s34 offen offset:0 sc1
    buffer_store_dwordx4 v[200:203], v1, s[8:11], s34 offen offset:1024 sc1
    s_add_u32 s34, s34, 0x20000
    v_pk_fma_f32 v[216:217], v[144:145], v[6:7], v[48:49] op_sel_hi:[1,0,1]
    v_pk_fma_f32 v[222:223], v[144:145], v[10:11], v[52:53] op_sel_hi:[1,0,1]
    v_pk_fma_f32 v[228:229], v[146:147], v[6:7], v[50:51] op_sel_hi:[1,0,1]
    v_pk_fma_f32 v[234:235], v[146:147], v[10:11], v[54:55] op_sel_hi:[1,0,1]
    v_pk_fma_f32 v[218:219], v[148:149], v[6:7], v[56:57] op_sel_hi:[1,0,1]
    v_pk_fma_f32 v[224:225], v[148:149], v[10:11], v[60:61] op_sel_hi:[1,0,1]
    v_pk_fma_f32 v[230:231], v[150:151], v[6:7], v[58:59] op_sel_hi:[1,0,1]
    v_pk_fma_f32 v[236:237], v[150:151], v[10:11], v[62:63] op_sel_hi:[1,0,1]
    v_pk_mul_f32 v[220:221], v[216:217], v[216:217]
    v_pk_mul_f32 v[226:227], v[222:223], v[222:223]
    v_pk_mul_f32 v[232:233], v[228:229], v[228:229]
    v_pk_mul_f32 v[238:239], v[234:235], v[234:235]
    v_pk_fma_f32 v[220:221], v[220:221], v[8:9], v[6:7] op_sel:[0,0,1] op_sel_hi:[1,0,1]
    v_pk_fma_f32 v[226:227], v[226:227], v[12:13], v[10:11] op_sel:[0,0,1] op_sel_hi:[1,0,1]
    v_pk_fma_f32 v[232:233], v[232:233], v[8:9], v[6:7] op_sel:[0,0,1] op_sel_hi:[1,0,1]
    v_pk_fma_f32 v[238:239], v[238:239], v[12:13], v[10:11] op_sel:[0,0,1] op_sel_hi:[1,0,1]
    v_pk_mul_f32 v[220:221], v[220:221], v[216:217]
    v_pk_mul_f32 v[226:227], v[226:227], v[222:223]
    v_pk_mul_f32 v[232:233], v[232:233], v[228:229]
    v_pk_mul_f32 v[238:239], v[238:239], v[234:235]
    v_exp_f32 v220, v220
    v_exp_f32 v226, v226
    v_exp_f32 v232, v232
    v_exp_f32 v238, v238
    v_exp_f32 v221, v221
    v_exp_f32 v227, v227
    v_exp_f32 v233, v233
    v_exp_f32 v239, v239
    v_pk_mul_f32 v[216:217], v[216:217], v[218:219]
    v_pk_mul_f32 v[222:223], v[222:223], v[224:225]
    v_pk_mul_f32 v[228:229], v[228:229], v[230:231]
    v_pk_mul_f32 v[234:235], v[234:235], v[236:237]
    v_pk_fma_f32 v[220:221], v[220:221], v[8:9], v[8:9] op_sel:[0,1,1] op_sel_hi:[1,1,1]
    v_pk_fma_f32 v[226:227], v[226:227], v[12:13], v[12:13] op_sel:[0,1,1] op_sel_hi:[1,1,1]
    v_pk_fma_f32 v[232:233], v[232:233], v[8:9], v[8:9] op_sel:[0,1,1] op_sel_hi:[1,1,1]
    v_pk_fma_f32 v[238:239], v[238:239], v[12:13], v[12:13] op_sel:[0,1,1] op_sel_hi:[1,1,1]
    v_rcp_f32 v220, v220
    v_rcp_f32 v226, v226
    v_rcp_f32 v232, v232
    v_rcp_f32 v238, v238
    v_rcp_f32 v221, v221
    v_rcp_f32 v227, v227
    v_rcp_f32 v233, v233
    v_rcp_f32 v239, v239
    v_pk_mul_f32 v[216:217], v[216:217], v[220:221]
    v_pk_mul_f32 v[222:223], v[222:223], v[226:227]
    v_pk_mul_f32 v[228:229], v[228:229], v[232:233]
    v_pk_mul_f32 v[234:235], v[234:235], v[238:239]
    v_cvt_pk_bf16_f32 v188, v216, v217
    v_cvt_pk_bf16_f32 v204, v222, v223
    v_cvt_pk_bf16_f32 v189, v228, v229
    v_cvt_pk_bf16_f32 v205, v234, v235
    v_pk_fma_f32 v[216:217], v[152:153], v[6:7], v[64:65] op_sel_hi:[1,0,1]
    v_pk_fma_f32 v[222:223], v[152:153], v[10:11], v[68:69] op_sel_hi:[1,0,1]
    v_pk_fma_f32 v[228:229], v[154:155], v[6:7], v[66:67] op_sel_hi:[1,0,1]
    v_pk_fma_f32 v[234:235], v[154:155], v[10:11], v[70:71] op_sel_hi:[1,0,1]
    v_pk_fma_f32 v[218:219], v[156:157], v[6:7], v[72:73] op_sel_hi:[1,0,1]
    v_pk_fma_f32 v[224:225], v[156:157], v[10:11], v[76:77] op_sel_hi:[1,0,1]
    v_pk_fma_f32 v[230:231], v[158:159], v[6:7], v[74:75] op_sel_hi:[1,0,1]
    v_pk_fma_f32 v[236:237], v[158:159], v[10:11], v[78:79] op_sel_hi:[1,0,1]
    v_pk_mul_f32 v[220:221], v[216:217], v[216:217]
    v_pk_mul_f32 v[226:227], v[222:223], v[222:223]
    v_pk_mul_f32 v[232:233], v[228:229], v[228:229]
    v_pk_mul_f32 v[238:239], v[234:235], v[234:235]
    v_pk_fma_f32 v[220:221], v[220:221], v[8:9], v[6:7] op_sel:[0,0,1] op_sel_hi:[1,0,1]
    v_pk_fma_f32 v[226:227], v[226:227], v[12:13], v[10:11] op_sel:[0,0,1] op_sel_hi:[1,0,1]
    v_pk_fma_f32 v[232:233], v[232:233], v[8:9], v[6:7] op_sel:[0,0,1] op_sel_hi:[1,0,1]
    v_pk_fma_f32 v[238:239], v[238:239], v[12:13], v[10:11] op_sel:[0,0,1] op_sel_hi:[1,0,1]
    v_pk_mul_f32 v[220:221], v[220:221], v[216:217]
    v_pk_mul_f32 v[226:227], v[226:227], v[222:223]
    v_pk_mul_f32 v[232:233], v[232:233], v[228:229]
    v_pk_mul_f32 v[238:239], v[238:239], v[234:235]
    v_exp_f32 v220, v220
    v_exp_f32 v226, v226
    v_exp_f32 v232, v232
    v_exp_f32 v238, v238
    v_exp_f32 v221, v221
    v_exp_f32 v227, v227
    v_exp_f32 v233, v233
    v_exp_f32 v239, v239
    v_pk_mul_f32 v[216:217], v[216:217], v[218:219]
    v_pk_mul_f32 v[222:223], v[222:223], v[224:225]
    v_pk_mul_f32 v[228:229], v[228:229], v[230:231]
    v_pk_mul_f32 v[234:235], v[234:235], v[236:237]
    v_pk_fma_f32 v[220:221], v[220:221], v[8:9], v[8:9] op_sel:[0,1,1] op_sel_hi:[1,1,1]
    v_pk_fma_f32 v[226:227], v[226:227], v[12:13], v[12:13] op_sel:[0,1,1] op_sel_hi:[1,1,1]
    v_pk_fma_f32 v[232:233], v[232:233], v[8:9], v[8:9] op_sel:[0,1,1] op_sel_hi:[1,1,1]
    v_pk_fma_f32 v[238:239], v[238:239], v[12:13], v[12:13] op_sel:[0,1,1] op_sel_hi:[1,1,1]
    v_rcp_f32 v220, v220
    v_rcp_f32 v226, v226
    v_rcp_f32 v232, v232
    v_rcp_f32 v238, v238
    v_rcp_f32 v221, v221
    v_rcp_f32 v227, v227
    v_rcp_f32 v233, v233
    v_rcp_f32 v239, v239
    v_pk_mul_f32 v[216:217], v[216:217], v[220:221]
    v_pk_mul_f32 v[222:223], v[222:223], v[226:227]
    v_pk_mul_f32 v[228:229], v[228:229], v[232:233]
    v_pk_mul_f32 v[234:235], v[234:235], v[238:239]
    v_cvt_pk_bf16_f32 v190, v216, v217
    v_cvt_pk_bf16_f32 v206, v222, v223
    v_cvt_pk_bf16_f32 v191, v228, v229
    v_cvt_pk_bf16_f32 v207, v234, v235
    buffer_store_dwordx4 v[188:191], v1, s[8:11], s34 offen offset:0 sc1
    buffer_store_dwordx4 v[204:207], v1, s[8:11], s34 offen offset:1024 sc1
    s_add_u32 s34, s34, 0x20000
    v_pk_fma_f32 v[216:217], v[160:161], v[6:7], v[80:81] op_sel_hi:[1,0,1]
    v_pk_fma_f32 v[222:223], v[160:161], v[10:11], v[84:85] op_sel_hi:[1,0,1]
    v_pk_fma_f32 v[228:229], v[162:163], v[6:7], v[82:83] op_sel_hi:[1,0,1]
    v_pk_fma_f32 v[234:235], v[162:163], v[10:11], v[86:87] op_sel_hi:[1,0,1]
    v_pk_fma_f32 v[218:219], v[164:165], v[6:7], v[88:89] op_sel_hi:[1,0,1]
    v_pk_fma_f32 v[224:225], v[164:165], v[10:11], v[92:93] op_sel_hi:[1,0,1]
    v_pk_fma_f32 v[230:231], v[166:167], v[6:7], v[90:91] op_sel_hi:[1,0,1]
    v_pk_fma_f32 v[236:237], v[166:167], v[10:11], v[94:95] op_sel_hi:[1,0,1]
    v_pk_mul_f32 v[220:221], v[216:217], v[216:217]
    v_pk_mul_f32 v[226:227], v[222:223], v[222:223]
    v_pk_mul_f32 v[232:233], v[228:229], v[228:229]
    v_pk_mul_f32 v[238:239], v[234:235], v[234:235]
    v_pk_fma_f32 v[220:221], v[220:221], v[8:9], v[6:7] op_sel:[0,0,1] op_sel_hi:[1,0,1]
    v_pk_fma_f32 v[226:227], v[226:227], v[12:13], v[10:11] op_sel:[0,0,1] op_sel_hi:[1,0,1]
    v_pk_fma_f32 v[232:233], v[232:233], v[8:9], v[6:7] op_sel:[0,0,1] op_sel_hi:[1,0,1]
    v_pk_fma_f32 v[238:239], v[238:239], v[12:13], v[10:11] op_sel:[0,0,1] op_sel_hi:[1,0,1]
    v_pk_mul_f32 v[220:221], v[220:221], v[216:217]
    v_pk_mul_f32 v[226:227], v[226:227], v[222:223]
    v_pk_mul_f32 v[232:233], v[232:233], v[228:229]
    v_pk_mul_f32 v[238:239], v[238:239], v[234:235]
    v_exp_f32 v220, v220
    v_exp_f32 v226, v226
    v_exp_f32 v232, v232
    v_exp_f32 v238, v238
    v_exp_f32 v221, v221
    v_exp_f32 v227, v227
    v_exp_f32 v233, v233
    v_exp_f32 v239, v239
    v_pk_mul_f32 v[216:217], v[216:217], v[218:219]
    v_pk_mul_f32 v[222:223], v[222:223], v[224:225]
    v_pk_mul_f32 v[228:229], v[228:229], v[230:231]
    v_pk_mul_f32 v[234:235], v[234:235], v[236:237]
    v_pk_fma_f32 v[220:221], v[220:221], v[8:9], v[8:9] op_sel:[0,1,1] op_sel_hi:[1,1,1]
    v_pk_fma_f32 v[226:227], v[226:227], v[12:13], v[12:13] op_sel:[0,1,1] op_sel_hi:[1,1,1]
    v_pk_fma_f32 v[232:233], v[232:233], v[8:9], v[8:9] op_sel:[0,1,1] op_sel_hi:[1,1,1]
    v_pk_fma_f32 v[238:239], v[238:239], v[12:13], v[12:13] op_sel:[0,1,1] op_sel_hi:[1,1,1]
    v_rcp_f32 v220, v220
    v_rcp_f32 v226, v226
    v_rcp_f32 v232, v232
    v_rcp_f32 v238, v238
    v_rcp_f32 v221, v221
    v_rcp_f32 v227, v227
    v_rcp_f32 v233, v233
    v_rcp_f32 v239, v239
    v_pk_mul_f32 v[216:217], v[216:217], v[220:221]
    v_pk_mul_f32 v[222:223], v[222:223], v[226:227]
    v_pk_mul_f32 v[228:229], v[228:229], v[232:233]
    v_pk_mul_f32 v[234:235], v[234:235], v[238:239]
    v_cvt_pk_bf16_f32 v192, v216, v217
    v_cvt_pk_bf16_f32 v208, v222, v223
    v_cvt_pk_bf16_f32 v193, v228, v229
    v_cvt_pk_bf16_f32 v209, v234, v235
    v_pk_fma_f32 v[216:217], v[168:169], v[6:7], v[96:97] op_sel_hi:[1,0,1]
    v_pk_fma_f32 v[222:223], v[168:169], v[10:11], v[100:101] op_sel_hi:[1,0,1]
    v_pk_fma_f32 v[228:229], v[170:171], v[6:7], v[98:99] op_sel_hi:[1,0,1]
    v_pk_fma_f32 v[234:235], v[170:171], v[10:11], v[102:103] op_sel_hi:[1,0,1]
    v_pk_fma_f32 v[218:219], v[172:173], v[6:7], v[104:105] op_sel_hi:[1,0,1]
    v_pk_fma_f32 v[224:225], v[172:173], v[10:11], v[108:109] op_sel_hi:[1,0,1]
    v_pk_fma_f32 v[230:231], v[174:175], v[6:7], v[106:107] op_sel_hi:[1,0,1]
    v_pk_fma_f32 v[236:237], v[174:175], v[10:11], v[110:111] op_sel_hi:[1,0,1]
    v_pk_mul_f32 v[220:221], v[216:217], v[216:217]
    v_pk_mul_f32 v[226:227], v[222:223], v[222:223]
    v_pk_mul_f32 v[232:233], v[228:229], v[228:229]
    v_pk_mul_f32 v[238:239], v[234:235], v[234:235]
    v_pk_fma_f32 v[220:221], v[220:221], v[8:9], v[6:7] op_sel:[0,0,1] op_sel_hi:[1,0,1]
    v_pk_fma_f32 v[226:227], v[226:227], v[12:13], v[10:11] op_sel:[0,0,1] op_sel_hi:[1,0,1]
    v_pk_fma_f32 v[232:233], v[232:233], v[8:9], v[6:7] op_sel:[0,0,1] op_sel_hi:[1,0,1]
    v_pk_fma_f32 v[238:239], v[238:239], v[12:13], v[10:11] op_sel:[0,0,1] op_sel_hi:[1,0,1]
    v_pk_mul_f32 v[220:221], v[220:221], v[216:217]
    v_pk_mul_f32 v[226:227], v[226:227], v[222:223]
    v_pk_mul_f32 v[232:233], v[232:233], v[228:229]
    v_pk_mul_f32 v[238:239], v[238:239], v[234:235]
    v_exp_f32 v220, v220
    v_exp_f32 v226, v226
    v_exp_f32 v232, v232
    v_exp_f32 v238, v238
    v_exp_f32 v221, v221
    v_exp_f32 v227, v227
    v_exp_f32 v233, v233
    v_exp_f32 v239, v239
    v_pk_mul_f32 v[216:217], v[216:217], v[218:219]
    v_pk_mul_f32 v[222:223], v[222:223], v[224:225]
    v_pk_mul_f32 v[228:229], v[228:229], v[230:231]
    v_pk_mul_f32 v[234:235], v[234:235], v[236:237]
    v_pk_fma_f32 v[220:221], v[220:221], v[8:9], v[8:9] op_sel:[0,1,1] op_sel_hi:[1,1,1]
    v_pk_fma_f32 v[226:227], v[226:227], v[12:13], v[12:13] op_sel:[0,1,1] op_sel_hi:[1,1,1]
    v_pk_fma_f32 v[232:233], v[232:233], v[8:9], v[8:9] op_sel:[0,1,1] op_sel_hi:[1,1,1]
    v_pk_fma_f32 v[238:239], v[238:239], v[12:13], v[12:13] op_sel:[0,1,1] op_sel_hi:[1,1,1]
    v_rcp_f32 v220, v220
    v_rcp_f32 v226, v226
    v_rcp_f32 v232, v232
    v_rcp_f32 v238, v238
    v_rcp_f32 v221, v221
    v_rcp_f32 v227, v227
    v_rcp_f32 v233, v233
    v_rcp_f32 v239, v239
    v_pk_mul_f32 v[216:217], v[216:217], v[220:221]
    v_pk_mul_f32 v[222:223], v[222:223], v[226:227]
    v_pk_mul_f32 v[228:229], v[228:229], v[232:233]
    v_pk_mul_f32 v[234:235], v[234:235], v[238:239]
    v_cvt_pk_bf16_f32 v194, v216, v217
    v_cvt_pk_bf16_f32 v210, v222, v223
    v_cvt_pk_bf16_f32 v195, v228, v229
    v_cvt_pk_bf16_f32 v211, v234, v235
    buffer_store_dwordx4 v[192:195], v1, s[8:11], s34 offen offset:0 sc1
    buffer_store_dwordx4 v[208:211], v1, s[8:11], s34 offen offset:1024 sc1
    v_pk_fma_f32 v[216:217], v[176:177], v[6:7], v[112:113] op_sel_hi:[1,0,1]
    v_pk_fma_f32 v[222:223], v[176:177], v[10:11], v[116:117] op_sel_hi:[1,0,1]
    v_pk_fma_f32 v[228:229], v[178:179], v[6:7], v[114:115] op_sel_hi:[1,0,1]
    v_pk_fma_f32 v[234:235], v[178:179], v[10:11], v[118:119] op_sel_hi:[1,0,1]
    v_pk_fma_f32 v[218:219], v[180:181], v[6:7], v[120:121] op_sel_hi:[1,0,1]
    v_pk_fma_f32 v[224:225], v[180:181], v[10:11], v[124:125] op_sel_hi:[1,0,1]
    v_pk_fma_f32 v[230:231], v[182:183], v[6:7], v[122:123] op_sel_hi:[1,0,1]
    v_pk_fma_f32 v[236:237], v[182:183], v[10:11], v[126:127] op_sel_hi:[1,0,1]
    v_pk_mul_f32 v[220:221], v[216:217], v[216:217]
    v_pk_mul_f32 v[226:227], v[222:223], v[222:223]
    v_pk_mul_f32 v[232:233], v[228:229], v[228:229]
    v_pk_mul_f32 v[238:239], v[234:235], v[234:235]
    v_pk_fma_f32 v[220:221], v[220:221], v[8:9], v[6:7] op_sel:[0,0,1] op_sel_hi:[1,0,1]
    v_pk_fma_f32 v[226:227], v[226:227], v[12:13], v[10:11] op_sel:[0,0,1] op_sel_hi:[1,0,1]
    v_pk_fma_f32 v[232:233], v[232:233], v[8:9], v[6:7] op_sel:[0,0,1] op_sel_hi:[1,0,1]
    v_pk_fma_f32 v[238:239], v[238:239], v[12:13], v[10:11] op_sel:[0,0,1] op_sel_hi:[1,0,1]
    v_pk_mul_f32 v[220:221], v[220:221], v[216:217]
    v_pk_mul_f32 v[226:227], v[226:227], v[222:223]
    v_pk_mul_f32 v[232:233], v[232:233], v[228:229]
    v_pk_mul_f32 v[238:239], v[238:239], v[234:235]
    v_exp_f32 v220, v220
    v_exp_f32 v226, v226
    v_exp_f32 v232, v232
    v_exp_f32 v238, v238
    v_exp_f32 v221, v221
    v_exp_f32 v227, v227
    v_exp_f32 v233, v233
    v_exp_f32 v239, v239
    v_pk_mul_f32 v[216:217], v[216:217], v[218:219]
    v_pk_mul_f32 v[222:223], v[222:223], v[224:225]
    v_pk_mul_f32 v[228:229], v[228:229], v[230:231]
    v_pk_mul_f32 v[234:235], v[234:235], v[236:237]
    v_pk_fma_f32 v[220:221], v[220:221], v[8:9], v[8:9] op_sel:[0,1,1] op_sel_hi:[1,1,1]
    v_pk_fma_f32 v[226:227], v[226:227], v[12:13], v[12:13] op_sel:[0,1,1] op_sel_hi:[1,1,1]
    v_pk_fma_f32 v[232:233], v[232:233], v[8:9], v[8:9] op_sel:[0,1,1] op_sel_hi:[1,1,1]
    v_pk_fma_f32 v[238:239], v[238:239], v[12:13], v[12:13] op_sel:[0,1,1] op_sel_hi:[1,1,1]
    v_rcp_f32 v220, v220
    v_rcp_f32 v226, v226
    v_rcp_f32 v232, v232
    v_rcp_f32 v238, v238
    v_rcp_f32 v221, v221
    v_rcp_f32 v227, v227
    v_rcp_f32 v233, v233
    v_rcp_f32 v239, v239
    v_pk_mul_f32 v[216:217], v[216:217], v[220:221]
    v_pk_mul_f32 v[222:223], v[222:223], v[226:227]
    v_pk_mul_f32 v[228:229], v[228:229], v[232:233]
    v_pk_mul_f32 v[234:235], v[234:235], v[238:239]
    v_cvt_pk_bf16_f32 v196, v216, v217
    v_cvt_pk_bf16_f32 v212, v222, v223
    v_cvt_pk_bf16_f32 v197, v228, v229
    v_cvt_pk_bf16_f32 v213, v234, v235
    buffer_store_dwordx2 v[196:197], v1, s[8:11], s32 offen offset:0 sc1
    buffer_store_dwordx2 v[212:213], v1, s[8:11], s32 offen offset:1024 sc1
K4_END:
    s_endpgm
.globl down_kernel
.p2align 8
.type down_kernel,@function
down_kernel:
    s_cmp_ge_u32 s2, 256
    s_cbranch_scc1 K5_END
    s_load_dwordx2 s[40:41], s[0:1], 72
    s_load_dwordx2 s[42:43], s[0:1], 56
    v_lshrrev_b32 v1, 6, v0
    v_and_b32 v0, 63, v0
    v_readfirstlane_b32 s3, v1
    s_nop 0
    s_cmp_lg_u32 s3, 0
    s_cbranch_scc1 CPF14_X
    v_min_u32 v2, 1, v0
    s_lshr_b32 s62, s2, 3
    s_mul_i32 s62, s62, 256
    v_lshl_add_u32 v2, v2, 7, s62
    v_min_u32 v2, TEXT_END-CPF14-4, v2
    s_getpc_b64 s[62:63]
CPF14:
    v_mov_b32 v3, s63
    v_add_co_u32 v2, vcc, s62, v2
    s_nop 1
    v_addc_co_u32 v3, vcc, 0, v3, vcc
    global_load_dword v4, v[2:3], off
CPF14_X:
    s_and_b32 s16, s2, 7
    s_lshr_b32 s17, s2, 3
    s_and_b32 s20, s16, 1
    s_lshr_b32 s18, s16, 1
    s_lshl_b32 s18, s18, 2
    s_and_b32 s19, s17, 3
    s_add_u32 s18, s18, s19
    s_lshr_b32 s21, s17, 2
    s_lshl_b32 s19, s21, 1
    s_add_u32 s19, s19, s20
    s_lshl_b32 s32, s18, 3
    s_lshl_b32 s33, s3, 1
    s_add_u32 s32, s32, s33
    s_mul_i32 s24, s20, 7168
    s_add_u32 s24, s24, s32
    s_lshl_b32 s24, s24, 10
    s_add_u32 s24, s24, 4194304
    s_add_u32 s23, s24, 131072
    s_mul_i32 s25, s19, 56
    s_lshr_b32 s26, s3, 1
    s_add_u32 s25, s25, s26
    s_lshl_b32 s25, s25, 1
    s_xor_b32 s26, s3, s20
    s_and_b32 s26, s26, 1
    s_add_u32 s25, s25, s26
    s_lshl_b32 s25, s25, 12
    s_add_u32 s25, s25, 50331648
    s_lshl_b32 s27, s3, 12
    s_lshl_b32 s35, s19, 8
    s_add_u32 s35, s35, s32
    s_lshl_b32 s35, s35, 10
    s_add_u32 s35, s35, 20971520
    s_add_u32 s36, s35, 0x20000
    v_lshlrev_b32 v1, 4, v0
    s_waitcnt lgkmcnt(0)
    s_mov_b32 s8, s40
    s_mov_b32 s9, s41
    s_mov_b32 s10, 0x10000000
    s_mov_b32 s11, 0x00020000
    s_mov_b32 s12, s42
    s_mov_b32 s13, s43
    s_mov_b32 s14, 0x400000
    s_mov_b32 s15, 0x00020000
    buffer_load_dwordx4 v[144:147], v1, s[8:11], s24 offen offset:0
    buffer_load_dwordx4 v[148:151], v1, s[8:11], s24 offen offset:1024
    s_add_u32 s24, s24, 262144
    s_add_u32 m0, s27, 0
    s_nop 0
    buffer_load_dwordx4 v1, s[8:11], s25 offen offset:0 lds
    buffer_load_dwordx4 v1, s[8:11], s25 offen offset:1024 lds
    buffer_load_dwordx4 v1, s[8:11], s25 offen offset:2048 lds
    buffer_load_dwordx4 v1, s[8:11], s25 offen offset:3072 lds
    s_add_u32 s25, s25, 16384
    buffer_load_dwordx4 v[152:155], v1, s[8:11], s23 offen offset:0
    buffer_load_dwordx4 v[156:159], v1, s[8:11], s23 offen offset:1024
    s_add_u32 s23, s23, 262144
    s_lshl_b32 s34, s32, 15
    s_lshl_b32 s33, s19, 7
    s_add_u32 s34, s34, s33
    s_add_u32 s37, s34, 0x8000
    s_lshl_b32 s38, s18, 4
    s_add_u32 s38, s38, s19
    s_lshl_b32 s38, s38, 2
    s_add_u32 s38, s38, s3
    s_lshl_b32 s38, s38, 12
    s_add_u32 s38, s38, 41943040
    s_xor_b32 s46, s38, 16384
    v_and_b32 v2, 15, v0
    v_lshlrev_b32 v2, 11, v2
    v_bfe_u32 v5, v0, 4, 1
    v_lshl_add_u32 v2, v5, 5, v2
    v_bfe_u32 v5, v0, 5, 1
    v_lshl_add_u32 v2, v5, 4, v2
    v_bfe_u32 v5, v0, 2, 2
    v_lshrrev_b32 v6, 4, v0
    v_cmp_eq_u32 vcc, v5, v6
    v_and_b32 v5, 1, v0
    v_lshlrev_b32 v5, 4, v5
    v_mov_b32 v6, 0x3f80
    v_lshlrev_b32 v6, v5, v6
    v_cndmask_b32 v6, 0, v6, vcc
    v_and_b32 v5, 2, v0
    v_cmp_eq_u32 vcc, 0, v5
    s_nop 1
    v_cndmask_b32 v8, 0, v6, vcc
    v_cndmask_b32 v9, v6, 0, vcc
    v_mov_b32 v10, 0
    v_mov_b32 v11, 0
    v_mov_b32 v12, 0
    v_mov_b32 v13, 0
    v_mov_b32 v14, v8
    v_mov_b32 v15, v9
    v_mov_b64 v[16:17], 0
    v_mov_b64 v[18:19], 0
    v_mov_b64 v[20:21], 0
    v_mov_b64 v[22:23], 0
    v_mov_b64 v[24:25], 0
    v_mov_b64 v[26:27], 0
    v_mov_b64 v[28:29], 0
    v_mov_b64 v[30:31], 0
    v_mov_b64 v[32:33], 0
    v_mov_b64 v[34:35], 0
    v_mov_b64 v[36:37], 0
    v_mov_b64 v[38:39], 0
    v_mov_b64 v[40:41], 0
    v_mov_b64 v[42:43], 0
    v_mov_b64 v[44:45], 0
    v_mov_b64 v[46:47], 0
    v_mov_b64 v[48:49], 0
    v_mov_b64 v[50:51], 0
    v_mov_b64 v[52:53], 0
    v_mov_b64 v[54:55], 0
    v_mov_b64 v[56:57], 0
    v_mov_b64 v[58:59], 0
    v_mov_b64 v[60:61], 0
    v_mov_b64 v[62:63], 0
    v_mov_b64 v[64:65], 0
    v_mov_b64 v[66:67], 0
    v_mov_b64 v[68:69], 0
    v_mov_b64 v[70:71], 0
    v_mov_b64 v[72:73], 0
    v_mov_b64 v[74:75], 0
    v_mov_b64 v[76:77], 0
    v_mov_b64 v[78:79], 0
    buffer_load_dwordx4 v[160:163], v1, s[8:11], s24 offen offset:0
    buffer_load_dwordx4 v[164:167], v1, s[8:11], s24 offen offset:1024
    s_add_u32 s24, s24, 262144
    s_add_u32 m0, s27, 16384
    s_nop 0
    buffer_load_dwordx4 v1, s[8:11], s25 offen offset:0 lds
    buffer_load_dwordx4 v1, s[8:11], s25 offen offset:1024 lds
    buffer_load_dwordx4 v1, s[8:11], s25 offen offset:2048 lds
    buffer_load_dwordx4 v1, s[8:11], s25 offen offset:3072 lds
    s_add_u32 s25, s25, 16384
    buffer_load_dwordx4 v[168:171], v1, s[8:11], s23 offen offset:0
    buffer_load_dwordx4 v[172:175], v1, s[8:11], s23 offen offset:1024
    s_add_u32 s23, s23, 262144
    buffer_load_dwordx4 v[176:179], v1, s[8:11], s24 offen offset:0
    buffer_load_dwordx4 v[180:183], v1, s[8:11], s24 offen offset:1024
    s_add_u32 s24, s24, 262144
    s_add_u32 m0, s27, 32768
    s_nop 0
    buffer_load_dwordx4 v1, s[8:11], s25 offen offset:0 lds
    buffer_load_dwordx4 v1, s[8:11], s25 offen offset:1024 lds
    buffer_load_dwordx4 v1, s[8:11], s25 offen offset:2048 lds
    buffer_load_dwordx4 v1, s[8:11], s25 offen offset:3072 lds
    s_add_u32 s25, s25, 16384
    buffer_load_dwordx4 v[184:187], v1, s[8:11], s23 offen offset:0
    buffer_load_dwordx4 v[188:191], v1, s[8:11], s23 offen offset:1024
    s_add_u32 s23, s23, 262144
    s_waitcnt vmcnt(16)
    s_barrier
    ds_read_b128 v[80:83], v1 offset:0
    ds_read_b128 v[84:87], v1 offset:1024
    ds_read_b128 v[88:91], v1 offset:2048
    ds_read_b128 v[92:95], v1 offset:3072
    ds_read_b128 v[96:99], v1 offset:4096
    ds_read_b128 v[100:103], v1 offset:5120
    ds_read_b128 v[104:107], v1 offset:6144
    ds_read_b128 v[108:111], v1 offset:7168
    buffer_load_dwordx4 v[192:195], v1, s[8:11], s24 offen offset:0
    buffer_load_dwordx4 v[196:199], v1, s[8:11], s24 offen offset:1024
    s_add_u32 s24, s24, 262144
    s_add_u32 m0, s27, 49152
    s_nop 0
    buffer_load_dwordx4 v1, s[8:11], s25 offen offset:0 lds
    buffer_load_dwordx4 v1, s[8:11], s25 offen offset:1024 lds
    buffer_load_dwordx4 v1, s[8:11], s25 offen offset:2048 lds
    s_mov_b32 s30, 6
L_k5_loop:
    s_waitcnt lgkmcnt(0)
    v_mfma_f32_16x16x32_bf16 v[16:19], v[80:83], v[144:147], v[16:19]
    ds_read_b128 v[112:115], v1 offset:8192
    v_mfma_f32_16x16x32_bf16 v[20:23], v[80:83], v[148:151], v[20:23]
    buffer_load_dwordx4 v1, s[8:11], s25 offen offset:3072 lds
    s_add_u32 s25, s25, 16384
    v_mfma_f32_16x16x32_bf16 v[24:27], v[84:87], v[144:147], v[24:27]
    ds_read_b128 v[116:119], v1 offset:9216
    v_mfma_f32_16x16x32_bf16 v[28:31], v[84:87], v[148:151], v[28:31]
    v_mfma_f32_16x16x32_bf16 v[32:35], v[88:91], v[144:147], v[32:35]
    ds_read_b128 v[120:123], v1 offset:10240
    buffer_load_dwordx4 v[200:203], v1, s[8:11], s23 offen offset:0
    v_mfma_f32_16x16x32_bf16 v[36:39], v[88:91], v[148:151], v[36:39]
    v_mfma_f32_16x16x32_bf16 v[40:43], v[92:95], v[144:147], v[40:43]
    ds_read_b128 v[124:127], v1 offset:11264
    v_mfma_f32_16x16x32_bf16 v[44:47], v[92:95], v[148:151], v[44:47]
    buffer_load_dwordx4 v[204:207], v1, s[8:11], s23 offen offset:1024
    s_add_u32 s23, s23, 262144
    v_mfma_f32_16x16x32_bf16 v[48:51], v[96:99], v[144:147], v[48:51]
    ds_read_b128 v[128:131], v1 offset:12288
    v_mfma_f32_16x16x32_bf16 v[52:55], v[96:99], v[148:151], v[52:55]
    v_mfma_f32_16x16x32_bf16 v[56:59], v[100:103], v[144:147], v[56:59]
    ds_read_b128 v[132:135], v1 offset:13312
    v_mfma_f32_16x16x32_bf16 v[60:63], v[100:103], v[148:151], v[60:63]
    v_mfma_f32_16x16x32_bf16 v[64:67], v[104:107], v[144:147], v[64:67]
    ds_read_b128 v[136:139], v1 offset:14336
    v_mfma_f32_16x16x32_bf16 v[68:71], v[104:107], v[148:151], v[68:71]
    v_mfma_f32_16x16x32_bf16 v[72:75], v[108:111], v[144:147], v[72:75]
    ds_read_b128 v[140:143], v1 offset:15360
    v_mfma_f32_16x16x32_bf16 v[76:79], v[108:111], v[148:151], v[76:79]
    s_waitcnt vmcnt(16) lgkmcnt(0)
    s_barrier
    v_mfma_f32_16x16x32_bf16 v[16:19], v[112:115], v[152:155], v[16:19]
    ds_read_b128 v[80:83], v1 offset:16384
    v_mfma_f32_16x16x32_bf16 v[20:23], v[112:115], v[156:159], v[20:23]
    v_mfma_f32_16x16x32_bf16 v[24:27], v[116:119], v[152:155], v[24:27]
    ds_read_b128 v[84:87], v1 offset:17408
    buffer_load_dwordx4 v[144:147], v1, s[8:11], s24 offen offset:0
    v_mfma_f32_16x16x32_bf16 v[28:31], v[116:119], v[156:159], v[28:31]
    v_mfma_f32_16x16x32_bf16 v[32:35], v[120:123], v[152:155], v[32:35]
    ds_read_b128 v[88:91], v1 offset:18432
    v_mfma_f32_16x16x32_bf16 v[36:39], v[120:123], v[156:159], v[36:39]
    buffer_load_dwordx4 v[148:151], v1, s[8:11], s24 offen offset:1024
    s_add_u32 s24, s24, 262144
    v_mfma_f32_16x16x32_bf16 v[40:43], v[124:127], v[152:155], v[40:43]
    ds_read_b128 v[92:95], v1 offset:19456
    v_mfma_f32_16x16x32_bf16 v[44:47], v[124:127], v[156:159], v[44:47]
    s_add_u32 m0, s27, 0
    v_mfma_f32_16x16x32_bf16 v[48:51], v[128:131], v[152:155], v[48:51]
    ds_read_b128 v[96:99], v1 offset:20480
    buffer_load_dwordx4 v1, s[8:11], s25 offen offset:0 lds
    v_mfma_f32_16x16x32_bf16 v[52:55], v[128:131], v[156:159], v[52:55]
    v_mfma_f32_16x16x32_bf16 v[56:59], v[132:135], v[152:155], v[56:59]
    ds_read_b128 v[100:103], v1 offset:21504
    v_mfma_f32_16x16x32_bf16 v[60:63], v[132:135], v[156:159], v[60:63]
    buffer_load_dwordx4 v1, s[8:11], s25 offen offset:1024 lds
    v_mfma_f32_16x16x32_bf16 v[64:67], v[136:139], v[152:155], v[64:67]
    ds_read_b128 v[104:107], v1 offset:22528
    v_mfma_f32_16x16x32_bf16 v[68:71], v[136:139], v[156:159], v[68:71]
    v_mfma_f32_16x16x32_bf16 v[72:75], v[140:143], v[152:155], v[72:75]
    ds_read_b128 v[108:111], v1 offset:23552
    buffer_load_dwordx4 v1, s[8:11], s25 offen offset:2048 lds
    v_mfma_f32_16x16x32_bf16 v[76:79], v[140:143], v[156:159], v[76:79]
    s_waitcnt lgkmcnt(0)
    v_mfma_f32_16x16x32_bf16 v[16:19], v[80:83], v[160:163], v[16:19]
    ds_read_b128 v[112:115], v1 offset:24576
    v_mfma_f32_16x16x32_bf16 v[20:23], v[80:83], v[164:167], v[20:23]
    buffer_load_dwordx4 v1, s[8:11], s25 offen offset:3072 lds
    s_add_u32 s25, s25, 16384
    v_mfma_f32_16x16x32_bf16 v[24:27], v[84:87], v[160:163], v[24:27]
    ds_read_b128 v[116:119], v1 offset:25600
    v_mfma_f32_16x16x32_bf16 v[28:31], v[84:87], v[164:167], v[28:31]
    v_mfma_f32_16x16x32_bf16 v[32:35], v[88:91], v[160:163], v[32:35]
    ds_read_b128 v[120:123], v1 offset:26624
    buffer_load_dwordx4 v[152:155], v1, s[8:11], s23 offen offset:0
    v_mfma_f32_16x16x32_bf16 v[36:39], v[88:91], v[164:167], v[36:39]
    v_mfma_f32_16x16x32_bf16 v[40:43], v[92:95], v[160:163], v[40:43]
    ds_read_b128 v[124:127], v1 offset:27648
    v_mfma_f32_16x16x32_bf16 v[44:47], v[92:95], v[164:167], v[44:47]
    buffer_load_dwordx4 v[156:159], v1, s[8:11], s23 offen offset:1024
    s_add_u32 s23, s23, 262144
    v_mfma_f32_16x16x32_bf16 v[48:51], v[96:99], v[160:163], v[48:51]
    ds_read_b128 v[128:131], v1 offset:28672
    v_mfma_f32_16x16x32_bf16 v[52:55], v[96:99], v[164:167], v[52:55]
    v_mfma_f32_16x16x32_bf16 v[56:59], v[100:103], v[160:163], v[56:59]
    ds_read_b128 v[132:135], v1 offset:29696
    v_mfma_f32_16x16x32_bf16 v[60:63], v[100:103], v[164:167], v[60:63]
    v_mfma_f32_16x16x32_bf16 v[64:67], v[104:107], v[160:163], v[64:67]
    ds_read_b128 v[136:139], v1 offset:30720
    v_mfma_f32_16x16x32_bf16 v[68:71], v[104:107], v[164:167], v[68:71]
    v_mfma_f32_16x16x32_bf16 v[72:75], v[108:111], v[160:163], v[72:75]
    ds_read_b128 v[140:143], v1 offset:31744
    v_mfma_f32_16x16x32_bf16 v[76:79], v[108:111], v[164:167], v[76:79]
    s_waitcnt vmcnt(16) lgkmcnt(0)
    s_barrier
    v_mfma_f32_16x16x32_bf16 v[16:19], v[112:115], v[168:171], v[16:19]
    ds_read_b128 v[80:83], v1 offset:32768
    v_mfma_f32_16x16x32_bf16 v[20:23], v[112:115], v[172:175], v[20:23]
    v_mfma_f32_16x16x32_bf16 v[24:27], v[116:119], v[168:171], v[24:27]
    ds_read_b128 v[84:87], v1 offset:33792
    buffer_load_dwordx4 v[160:163], v1, s[8:11], s24 offen offset:0
    v_mfma_f32_16x16x32_bf16 v[28:31], v[116:119], v[172:175], v[28:31]
    v_mfma_f32_16x16x32_bf16 v[32:35], v[120:123], v[168:171], v[32:35]
    ds_read_b128 v[88:91], v1 offset:34816
    v_mfma_f32_16x16x32_bf16 v[36:39], v[120:123], v[172:175], v[36:39]
    buffer_load_dwordx4 v[164:167], v1, s[8:11], s24 offen offset:1024
    s_add_u32 s24, s24, 262144
    v_mfma_f32_16x16x32_bf16 v[40:43], v[124:127], v[168:171], v[40:43]
    ds_read_b128 v[92:95], v1 offset:35840
    v_mfma_f32_16x16x32_bf16 v[44:47], v[124:127], v[172:175], v[44:47]
    s_add_u32 m0, s27, 16384
    v_mfma_f32_16x16x32_bf16 v[48:51], v[128:131], v[168:171], v[48:51]
    ds_read_b128 v[96:99], v1 offset:36864
    buffer_load_dwordx4 v1, s[8:11], s25 offen offset:0 lds
    v_mfma_f32_16x16x32_bf16 v[52:55], v[128:131], v[172:175], v[52:55]
    v_mfma_f32_16x16x32_bf16 v[56:59], v[132:135], v[168:171], v[56:59]
    ds_read_b128 v[100:103], v1 offset:37888
    v_mfma_f32_16x16x32_bf16 v[60:63], v[132:135], v[172:175], v[60:63]
    buffer_load_dwordx4 v1, s[8:11], s25 offen offset:1024 lds
    v_mfma_f32_16x16x32_bf16 v[64:67], v[136:139], v[168:171], v[64:67]
    ds_read_b128 v[104:107], v1 offset:38912
    v_mfma_f32_16x16x32_bf16 v[68:71], v[136:139], v[172:175], v[68:71]
    v_mfma_f32_16x16x32_bf16 v[72:75], v[140:143], v[168:171], v[72:75]
    ds_read_b128 v[108:111], v1 offset:39936
    buffer_load_dwordx4 v1, s[8:11], s25 offen offset:2048 lds
    v_mfma_f32_16x16x32_bf16 v[76:79], v[140:143], v[172:175], v[76:79]
    s_waitcnt lgkmcnt(0)
    v_mfma_f32_16x16x32_bf16 v[16:19], v[80:83], v[176:179], v[16:19]
    ds_read_b128 v[112:115], v1 offset:40960
    v_mfma_f32_16x16x32_bf16 v[20:23], v[80:83], v[180:183], v[20:23]
    buffer_load_dwordx4 v1, s[8:11], s25 offen offset:3072 lds
    s_add_u32 s25, s25, 16384
    v_mfma_f32_16x16x32_bf16 v[24:27], v[84:87], v[176:179], v[24:27]
    ds_read_b128 v[116:119], v1 offset:41984
    v_mfma_f32_16x16x32_bf16 v[28:31], v[84:87], v[180:183], v[28:31]
    v_mfma_f32_16x16x32_bf16 v[32:35], v[88:91], v[176:179], v[32:35]
    ds_read_b128 v[120:123], v1 offset:43008
    buffer_load_dwordx4 v[168:171], v1, s[8:11], s23 offen offset:0
    v_mfma_f32_16x16x32_bf16 v[36:39], v[88:91], v[180:183], v[36:39]
    v_mfma_f32_16x16x32_bf16 v[40:43], v[92:95], v[176:179], v[40:43]
    ds_read_b128 v[124:127], v1 offset:44032
    v_mfma_f32_16x16x32_bf16 v[44:47], v[92:95], v[180:183], v[44:47]
    buffer_load_dwordx4 v[172:175], v1, s[8:11], s23 offen offset:1024
    s_add_u32 s23, s23, 262144
    v_mfma_f32_16x16x32_bf16 v[48:51], v[96:99], v[176:179], v[48:51]
    ds_read_b128 v[128:131], v1 offset:45056
    v_mfma_f32_16x16x32_bf16 v[52:55], v[96:99], v[180:183], v[52:55]
    v_mfma_f32_16x16x32_bf16 v[56:59], v[100:103], v[176:179], v[56:59]
    ds_read_b128 v[132:135], v1 offset:46080
    v_mfma_f32_16x16x32_bf16 v[60:63], v[100:103], v[180:183], v[60:63]
    v_mfma_f32_16x16x32_bf16 v[64:67], v[104:107], v[176:179], v[64:67]
    ds_read_b128 v[136:139], v1 offset:47104
    v_mfma_f32_16x16x32_bf16 v[68:71], v[104:107], v[180:183], v[68:71]
    v_mfma_f32_16x16x32_bf16 v[72:75], v[108:111], v[176:179], v[72:75]
    ds_read_b128 v[140:143], v1 offset:48128
    v_mfma_f32_16x16x32_bf16 v[76:79], v[108:111], v[180:183], v[76:79]
    s_waitcnt vmcnt(16) lgkmcnt(0)
    s_barrier
    v_mfma_f32_16x16x32_bf16 v[16:19], v[112:115], v[184:187], v[16:19]
    ds_read_b128 v[80:83], v1 offset:49152
    v_mfma_f32_16x16x32_bf16 v[20:23], v[112:115], v[188:191], v[20:23]
    v_mfma_f32_16x16x32_bf16 v[24:27], v[116:119], v[184:187], v[24:27]
    ds_read_b128 v[84:87], v1 offset:50176
    buffer_load_dwordx4 v[176:179], v1, s[8:11], s24 offen offset:0
    v_mfma_f32_16x16x32_bf16 v[28:31], v[116:119], v[188:191], v[28:31]
    v_mfma_f32_16x16x32_bf16 v[32:35], v[120:123], v[184:187], v[32:35]
    ds_read_b128 v[88:91], v1 offset:51200
    v_mfma_f32_16x16x32_bf16 v[36:39], v[120:123], v[188:191], v[36:39]
    buffer_load_dwordx4 v[180:183], v1, s[8:11], s24 offen offset:1024
    s_add_u32 s24, s24, 262144
    v_mfma_f32_16x16x32_bf16 v[40:43], v[124:127], v[184:187], v[40:43]
    ds_read_b128 v[92:95], v1 offset:52224
    v_mfma_f32_16x16x32_bf16 v[44:47], v[124:127], v[188:191], v[44:47]
    s_add_u32 m0, s27, 32768
    v_mfma_f32_16x16x32_bf16 v[48:51], v[128:131], v[184:187], v[48:51]
    ds_read_b128 v[96:99], v1 offset:53248
    buffer_load_dwordx4 v1, s[8:11], s25 offen offset:0 lds
    v_mfma_f32_16x16x32_bf16 v[52:55], v[128:131], v[188:191], v[52:55]
    v_mfma_f32_16x16x32_bf16 v[56:59], v[132:135], v[184:187], v[56:59]
    ds_read_b128 v[100:103], v1 offset:54272
    v_mfma_f32_16x16x32_bf16 v[60:63], v[132:135], v[188:191], v[60:63]
    buffer_load_dwordx4 v1, s[8:11], s25 offen offset:1024 lds
    v_mfma_f32_16x16x32_bf16 v[64:67], v[136:139], v[184:187], v[64:67]
    ds_read_b128 v[104:107], v1 offset:55296
    v_mfma_f32_16x16x32_bf16 v[68:71], v[136:139], v[188:191], v[68:71]
    v_mfma_f32_16x16x32_bf16 v[72:75], v[140:143], v[184:187], v[72:75]
    ds_read_b128 v[108:111], v1 offset:56320
    buffer_load_dwordx4 v1, s[8:11], s25 offen offset:2048 lds
    v_mfma_f32_16x16x32_bf16 v[76:79], v[140:143], v[188:191], v[76:79]
    s_waitcnt lgkmcnt(0)
    v_mfma_f32_16x16x32_bf16 v[16:19], v[80:83], v[192:195], v[16:19]
    ds_read_b128 v[112:115], v1 offset:57344
    v_mfma_f32_16x16x32_bf16 v[20:23], v[80:83], v[196:199], v[20:23]
    buffer_load_dwordx4 v1, s[8:11], s25 offen offset:3072 lds
    s_add_u32 s25, s25, 16384
    v_mfma_f32_16x16x32_bf16 v[24:27], v[84:87], v[192:195], v[24:27]
    ds_read_b128 v[116:119], v1 offset:58368
    v_mfma_f32_16x16x32_bf16 v[28:31], v[84:87], v[196:199], v[28:31]
    v_mfma_f32_16x16x32_bf16 v[32:35], v[88:91], v[192:195], v[32:35]
    ds_read_b128 v[120:123], v1 offset:59392
    buffer_load_dwordx4 v[184:187], v1, s[8:11], s23 offen offset:0
    v_mfma_f32_16x16x32_bf16 v[36:39], v[88:91], v[196:199], v[36:39]
    v_mfma_f32_16x16x32_bf16 v[40:43], v[92:95], v[192:195], v[40:43]
    ds_read_b128 v[124:127], v1 offset:60416
    v_mfma_f32_16x16x32_bf16 v[44:47], v[92:95], v[196:199], v[44:47]
    buffer_load_dwordx4 v[188:191], v1, s[8:11], s23 offen offset:1024
    s_add_u32 s23, s23, 262144
    v_mfma_f32_16x16x32_bf16 v[48:51], v[96:99], v[192:195], v[48:51]
    ds_read_b128 v[128:131], v1 offset:61440
    v_mfma_f32_16x16x32_bf16 v[52:55], v[96:99], v[196:199], v[52:55]
    v_mfma_f32_16x16x32_bf16 v[56:59], v[100:103], v[192:195], v[56:59]
    ds_read_b128 v[132:135], v1 offset:62464
    v_mfma_f32_16x16x32_bf16 v[60:63], v[100:103], v[196:199], v[60:63]
    v_mfma_f32_16x16x32_bf16 v[64:67], v[104:107], v[192:195], v[64:67]
    ds_read_b128 v[136:139], v1 offset:63488
    v_mfma_f32_16x16x32_bf16 v[68:71], v[104:107], v[196:199], v[68:71]
    v_mfma_f32_16x16x32_bf16 v[72:75], v[108:111], v[192:195], v[72:75]
    ds_read_b128 v[140:143], v1 offset:64512
    v_mfma_f32_16x16x32_bf16 v[76:79], v[108:111], v[196:199], v[76:79]
    s_waitcnt vmcnt(16) lgkmcnt(0)
    s_barrier
    v_mfma_f32_16x16x32_bf16 v[16:19], v[112:115], v[200:203], v[16:19]
    ds_read_b128 v[80:83], v1 offset:0
    v_mfma_f32_16x16x32_bf16 v[20:23], v[112:115], v[204:207], v[20:23]
    v_mfma_f32_16x16x32_bf16 v[24:27], v[116:119], v[200:203], v[24:27]
    ds_read_b128 v[84:87], v1 offset:1024
    buffer_load_dwordx4 v[192:195], v1, s[8:11], s24 offen offset:0
    v_mfma_f32_16x16x32_bf16 v[28:31], v[116:119], v[204:207], v[28:31]
    v_mfma_f32_16x16x32_bf16 v[32:35], v[120:123], v[200:203], v[32:35]
    ds_read_b128 v[88:91], v1 offset:2048
    v_mfma_f32_16x16x32_bf16 v[36:39], v[120:123], v[204:207], v[36:39]
    buffer_load_dwordx4 v[196:199], v1, s[8:11], s24 offen offset:1024
    s_add_u32 s24, s24, 262144
    v_mfma_f32_16x16x32_bf16 v[40:43], v[124:127], v[200:203], v[40:43]
    ds_read_b128 v[92:95], v1 offset:3072
    v_mfma_f32_16x16x32_bf16 v[44:47], v[124:127], v[204:207], v[44:47]
    s_add_u32 m0, s27, 49152
    v_mfma_f32_16x16x32_bf16 v[48:51], v[128:131], v[200:203], v[48:51]
    ds_read_b128 v[96:99], v1 offset:4096
    buffer_load_dwordx4 v1, s[8:11], s25 offen offset:0 lds
    v_mfma_f32_16x16x32_bf16 v[52:55], v[128:131], v[204:207], v[52:55]
    v_mfma_f32_16x16x32_bf16 v[56:59], v[132:135], v[200:203], v[56:59]
    ds_read_b128 v[100:103], v1 offset:5120
    v_mfma_f32_16x16x32_bf16 v[60:63], v[132:135], v[204:207], v[60:63]
    buffer_load_dwordx4 v1, s[8:11], s25 offen offset:1024 lds
    v_mfma_f32_16x16x32_bf16 v[64:67], v[136:139], v[200:203], v[64:67]
    ds_read_b128 v[104:107], v1 offset:6144
    v_mfma_f32_16x16x32_bf16 v[68:71], v[136:139], v[204:207], v[68:71]
    v_mfma_f32_16x16x32_bf16 v[72:75], v[140:143], v[200:203], v[72:75]
    ds_read_b128 v[108:111], v1 offset:7168
    buffer_load_dwordx4 v1, s[8:11], s25 offen offset:2048 lds
    v_mfma_f32_16x16x32_bf16 v[76:79], v[140:143], v[204:207], v[76:79]
    s_sub_u32 s30, s30, 1
    s_cmp_lg_u32 s30, 0
    s_cbranch_scc1 L_k5_loop
    s_waitcnt lgkmcnt(0)
    v_mfma_f32_16x16x32_bf16 v[16:19], v[80:83], v[144:147], v[16:19]
    ds_read_b128 v[112:115], v1 offset:8192
    v_mfma_f32_16x16x32_bf16 v[20:23], v[80:83], v[148:151], v[20:23]
    buffer_load_dwordx4 v1, s[8:11], s25 offen offset:3072 lds
    s_add_u32 s25, s25, 16384
    v_mfma_f32_16x16x32_bf16 v[24:27], v[84:87], v[144:147], v[24:27]
    ds_read_b128 v[116:119], v1 offset:9216
    v_mfma_f32_16x16x32_bf16 v[28:31], v[84:87], v[148:151], v[28:31]
    v_mfma_f32_16x16x32_bf16 v[32:35], v[88:91], v[144:147], v[32:35]
    ds_read_b128 v[120:123], v1 offset:10240
    buffer_load_dwordx4 v[200:203], v1, s[8:11], s23 offen offset:0
    v_mfma_f32_16x16x32_bf16 v[36:39], v[88:91], v[148:151], v[36:39]
    v_mfma_f32_16x16x32_bf16 v[40:43], v[92:95], v[144:147], v[40:43]
    ds_read_b128 v[124:127], v1 offset:11264
    v_mfma_f32_16x16x32_bf16 v[44:47], v[92:95], v[148:151], v[44:47]
    buffer_load_dwordx4 v[204:207], v1, s[8:11], s23 offen offset:1024
    s_add_u32 s23, s23, 262144
    v_mfma_f32_16x16x32_bf16 v[48:51], v[96:99], v[144:147], v[48:51]
    ds_read_b128 v[128:131], v1 offset:12288
    v_mfma_f32_16x16x32_bf16 v[52:55], v[96:99], v[148:151], v[52:55]
    v_mfma_f32_16x16x32_bf16 v[56:59], v[100:103], v[144:147], v[56:59]
    ds_read_b128 v[132:135], v1 offset:13312
    v_mfma_f32_16x16x32_bf16 v[60:63], v[100:103], v[148:151], v[60:63]
    v_mfma_f32_16x16x32_bf16 v[64:67], v[104:107], v[144:147], v[64:67]
    ds_read_b128 v[136:139], v1 offset:14336
    v_mfma_f32_16x16x32_bf16 v[68:71], v[104:107], v[148:151], v[68:71]
    v_mfma_f32_16x16x32_bf16 v[72:75], v[108:111], v[144:147], v[72:75]
    ds_read_b128 v[140:143], v1 offset:15360
    v_mfma_f32_16x16x32_bf16 v[76:79], v[108:111], v[148:151], v[76:79]
    s_waitcnt vmcnt(16) lgkmcnt(0)
    s_barrier
    v_mfma_f32_16x16x32_bf16 v[16:19], v[112:115], v[152:155], v[16:19]
    ds_read_b128 v[80:83], v1 offset:16384
    v_mfma_f32_16x16x32_bf16 v[20:23], v[112:115], v[156:159], v[20:23]
    v_mfma_f32_16x16x32_bf16 v[24:27], v[116:119], v[152:155], v[24:27]
    ds_read_b128 v[84:87], v1 offset:17408
    v_mfma_f32_16x16x32_bf16 v[28:31], v[116:119], v[156:159], v[28:31]
    v_mfma_f32_16x16x32_bf16 v[32:35], v[120:123], v[152:155], v[32:35]
    ds_read_b128 v[88:91], v1 offset:18432
    v_mfma_f32_16x16x32_bf16 v[36:39], v[120:123], v[156:159], v[36:39]
    v_mfma_f32_16x16x32_bf16 v[40:43], v[124:127], v[152:155], v[40:43]
    ds_read_b128 v[92:95], v1 offset:19456
    v_mfma_f32_16x16x32_bf16 v[44:47], v[124:127], v[156:159], v[44:47]
    v_mfma_f32_16x16x32_bf16 v[48:51], v[128:131], v[152:155], v[48:51]
    ds_read_b128 v[96:99], v1 offset:20480
    v_mfma_f32_16x16x32_bf16 v[52:55], v[128:131], v[156:159], v[52:55]
    v_mfma_f32_16x16x32_bf16 v[56:59], v[132:135], v[152:155], v[56:59]
    ds_read_b128 v[100:103], v1 offset:21504
    v_mfma_f32_16x16x32_bf16 v[60:63], v[132:135], v[156:159], v[60:63]
    v_mfma_f32_16x16x32_bf16 v[64:67], v[136:139], v[152:155], v[64:67]
    ds_read_b128 v[104:107], v1 offset:22528
    v_mfma_f32_16x16x32_bf16 v[68:71], v[136:139], v[156:159], v[68:71]
    v_mfma_f32_16x16x32_bf16 v[72:75], v[140:143], v[152:155], v[72:75]
    ds_read_b128 v[108:111], v1 offset:23552
    v_mfma_f32_16x16x32_bf16 v[76:79], v[140:143], v[156:159], v[76:79]
    s_waitcnt lgkmcnt(0)
    v_mfma_f32_16x16x32_bf16 v[16:19], v[80:83], v[160:163], v[16:19]
    ds_read_b128 v[112:115], v1 offset:24576
    v_mfma_f32_16x16x32_bf16 v[20:23], v[80:83], v[164:167], v[20:23]
    v_mfma_f32_16x16x32_bf16 v[24:27], v[84:87], v[160:163], v[24:27]
    ds_read_b128 v[116:119], v1 offset:25600
    v_mfma_f32_16x16x32_bf16 v[28:31], v[84:87], v[164:167], v[28:31]
    v_mfma_f32_16x16x32_bf16 v[32:35], v[88:91], v[160:163], v[32:35]
    ds_read_b128 v[120:123], v1 offset:26624
    v_mfma_f32_16x16x32_bf16 v[36:39], v[88:91], v[164:167], v[36:39]
    v_mfma_f32_16x16x32_bf16 v[40:43], v[92:95], v[160:163], v[40:43]
    ds_read_b128 v[124:127], v1 offset:27648
    v_mfma_f32_16x16x32_bf16 v[44:47], v[92:95], v[164:167], v[44:47]
    v_mfma_f32_16x16x32_bf16 v[48:51], v[96:99], v[160:163], v[48:51]
    ds_read_b128 v[128:131], v1 offset:28672
    v_mfma_f32_16x16x32_bf16 v[52:55], v[96:99], v[164:167], v[52:55]
    v_mfma_f32_16x16x32_bf16 v[56:59], v[100:103], v[160:163], v[56:59]
    ds_read_b128 v[132:135], v1 offset:29696
    v_mfma_f32_16x16x32_bf16 v[60:63], v[100:103], v[164:167], v[60:63]
    v_mfma_f32_16x16x32_bf16 v[64:67], v[104:107], v[160:163], v[64:67]
    ds_read_b128 v[136:139], v1 offset:30720
    v_mfma_f32_16x16x32_bf16 v[68:71], v[104:107], v[164:167], v[68:71]
    v_mfma_f32_16x16x32_bf16 v[72:75], v[108:111], v[160:163], v[72:75]
    ds_read_b128 v[140:143], v1 offset:31744
    v_mfma_f32_16x16x32_bf16 v[76:79], v[108:111], v[164:167], v[76:79]
    s_waitcnt vmcnt(8) lgkmcnt(0)
    s_barrier
    v_mfma_f32_16x16x32_bf16 v[16:19], v[112:115], v[168:171], v[16:19]
    ds_read_b128 v[80:83], v1 offset:32768
    v_mfma_f32_16x16x32_bf16 v[20:23], v[112:115], v[172:175], v[20:23]
    v_mfma_f32_16x16x32_bf16 v[24:27], v[116:119], v[168:171], v[24:27]
    ds_read_b128 v[84:87], v1 offset:33792
    v_mfma_f32_16x16x32_bf16 v[28:31], v[116:119], v[172:175], v[28:31]
    v_mfma_f32_16x16x32_bf16 v[32:35], v[120:123], v[168:171], v[32:35]
    ds_read_b128 v[88:91], v1 offset:34816
    v_mfma_f32_16x16x32_bf16 v[36:39], v[120:123], v[172:175], v[36:39]
    v_mfma_f32_16x16x32_bf16 v[40:43], v[124:127], v[168:171], v[40:43]
    ds_read_b128 v[92:95], v1 offset:35840
    v_mfma_f32_16x16x32_bf16 v[44:47], v[124:127], v[172:175], v[44:47]
    v_mfma_f32_16x16x32_bf16 v[48:51], v[128:131], v[168:171], v[48:51]
    ds_read_b128 v[96:99], v1 offset:36864
    v_mfma_f32_16x16x32_bf16 v[52:55], v[128:131], v[172:175], v[52:55]
    v_mfma_f32_16x16x32_bf16 v[56:59], v[132:135], v[168:171], v[56:59]
    ds_read_b128 v[100:103], v1 offset:37888
    v_mfma_f32_16x16x32_bf16 v[60:63], v[132:135], v[172:175], v[60:63]
    v_mfma_f32_16x16x32_bf16 v[64:67], v[136:139], v[168:171], v[64:67]
    ds_read_b128 v[104:107], v1 offset:38912
    v_mfma_f32_16x16x32_bf16 v[68:71], v[136:139], v[172:175], v[68:71]
    v_mfma_f32_16x16x32_bf16 v[72:75], v[140:143], v[168:171], v[72:75]
    ds_read_b128 v[108:111], v1 offset:39936
    v_mfma_f32_16x16x32_bf16 v[76:79], v[140:143], v[172:175], v[76:79]
    s_waitcnt lgkmcnt(0)
    v_mfma_f32_16x16x32_bf16 v[16:19], v[80:83], v[176:179], v[16:19]
    ds_read_b128 v[112:115], v1 offset:40960
    v_mfma_f32_16x16x32_bf16 v[20:23], v[80:83], v[180:183], v[20:23]
    buffer_load_dwordx4 v[208:211], v1, s[8:11], s35 offen offset:0
    v_mfma_f32_16x16x32_bf16 v[24:27], v[84:87], v[176:179], v[24:27]
    ds_read_b128 v[116:119], v1 offset:41984
    v_mfma_f32_16x16x32_bf16 v[28:31], v[84:87], v[180:183], v[28:31]
    buffer_load_dwordx4 v[212:215], v1, s[8:11], s35 offen offset:1024
    v_mfma_f32_16x16x32_bf16 v[32:35], v[88:91], v[176:179], v[32:35]
    ds_read_b128 v[120:123], v1 offset:43008
    v_mfma_f32_16x16x32_bf16 v[36:39], v[88:91], v[180:183], v[36:39]
    buffer_load_dwordx4 v[216:219], v1, s[8:11], s36 offen offset:0
    v_mfma_f32_16x16x32_bf16 v[40:43], v[92:95], v[176:179], v[40:43]
    ds_read_b128 v[124:127], v1 offset:44032
    v_mfma_f32_16x16x32_bf16 v[44:47], v[92:95], v[180:183], v[44:47]
    buffer_load_dwordx4 v[220:223], v1, s[8:11], s36 offen offset:1024
    v_mfma_f32_16x16x32_bf16 v[48:51], v[96:99], v[176:179], v[48:51]
    ds_read_b128 v[128:131], v1 offset:45056
    v_mfma_f32_16x16x32_bf16 v[52:55], v[96:99], v[180:183], v[52:55]
    v_mfma_f32_16x16x32_bf16 v[56:59], v[100:103], v[176:179], v[56:59]
    ds_read_b128 v[132:135], v1 offset:46080
    v_mfma_f32_16x16x32_bf16 v[60:63], v[100:103], v[180:183], v[60:63]
    v_mfma_f32_16x16x32_bf16 v[64:67], v[104:107], v[176:179], v[64:67]
    ds_read_b128 v[136:139], v1 offset:47104
    v_mfma_f32_16x16x32_bf16 v[68:71], v[104:107], v[180:183], v[68:71]
    v_mfma_f32_16x16x32_bf16 v[72:75], v[108:111], v[176:179], v[72:75]
    ds_read_b128 v[140:143], v1 offset:48128
    v_mfma_f32_16x16x32_bf16 v[76:79], v[108:111], v[180:183], v[76:79]
    s_waitcnt vmcnt(4) lgkmcnt(0)
    s_barrier
    v_mfma_f32_16x16x32_bf16 v[16:19], v[112:115], v[184:187], v[16:19]
    ds_read_b128 v[80:83], v1 offset:49152
    v_mfma_f32_16x16x32_bf16 v[20:23], v[112:115], v[188:191], v[20:23]
    v_mfma_f32_16x16x32_bf16 v[24:27], v[116:119], v[184:187], v[24:27]
    ds_read_b128 v[84:87], v1 offset:50176
    v_mfma_f32_16x16x32_bf16 v[28:31], v[116:119], v[188:191], v[28:31]
    v_mfma_f32_16x16x32_bf16 v[32:35], v[120:123], v[184:187], v[32:35]
    ds_read_b128 v[88:91], v1 offset:51200
    v_mfma_f32_16x16x32_bf16 v[36:39], v[120:123], v[188:191], v[36:39]
    v_mfma_f32_16x16x32_bf16 v[40:43], v[124:127], v[184:187], v[40:43]
    ds_read_b128 v[92:95], v1 offset:52224
    v_mfma_f32_16x16x32_bf16 v[44:47], v[124:127], v[188:191], v[44:47]
    v_mfma_f32_16x16x32_bf16 v[48:51], v[128:131], v[184:187], v[48:51]
    ds_read_b128 v[96:99], v1 offset:53248
    v_mfma_f32_16x16x32_bf16 v[52:55], v[128:131], v[188:191], v[52:55]
    v_mfma_f32_16x16x32_bf16 v[56:59], v[132:135], v[184:187], v[56:59]
    ds_read_b128 v[100:103], v1 offset:54272
    v_mfma_f32_16x16x32_bf16 v[60:63], v[132:135], v[188:191], v[60:63]
    v_mfma_f32_16x16x32_bf16 v[64:67], v[136:139], v[184:187], v[64:67]
    ds_read_b128 v[104:107], v1 offset:55296
    v_mfma_f32_16x16x32_bf16 v[68:71], v[136:139], v[188:191], v[68:71]
    v_mfma_f32_16x16x32_bf16 v[72:75], v[140:143], v[184:187], v[72:75]
    ds_read_b128 v[108:111], v1 offset:56320
    v_mfma_f32_16x16x32_bf16 v[76:79], v[140:143], v[188:191], v[76:79]
    s_waitcnt lgkmcnt(0)
    v_mfma_f32_16x16x32_bf16 v[16:19], v[80:83], v[192:195], v[16:19]
    ds_read_b128 v[112:115], v1 offset:57344
    v_mfma_f32_16x16x32_bf16 v[20:23], v[80:83], v[196:199], v[20:23]
    v_mfma_f32_16x16x32_bf16 v[24:27], v[84:87], v[192:195], v[24:27]
    ds_read_b128 v[116:119], v1 offset:58368
    v_mfma_f32_16x16x32_bf16 v[28:31], v[84:87], v[196:199], v[28:31]
    v_mfma_f32_16x16x32_bf16 v[32:35], v[88:91], v[192:195], v[32:35]
    ds_read_b128 v[120:123], v1 offset:59392
    v_mfma_f32_16x16x32_bf16 v[36:39], v[88:91], v[196:199], v[36:39]
    v_mfma_f32_16x16x32_bf16 v[40:43], v[92:95], v[192:195], v[40:43]
    ds_read_b128 v[124:127], v1 offset:60416
    v_mfma_f32_16x16x32_bf16 v[44:47], v[92:95], v[196:199], v[44:47]
    v_mfma_f32_16x16x32_bf16 v[48:51], v[96:99], v[192:195], v[48:51]
    ds_read_b128 v[128:131], v1 offset:61440
    v_mfma_f32_16x16x32_bf16 v[52:55], v[96:99], v[196:199], v[52:55]
    v_mfma_f32_16x16x32_bf16 v[56:59], v[100:103], v[192:195], v[56:59]
    ds_read_b128 v[132:135], v1 offset:62464
    v_mfma_f32_16x16x32_bf16 v[60:63], v[100:103], v[196:199], v[60:63]
    v_mfma_f32_16x16x32_bf16 v[64:67], v[104:107], v[192:195], v[64:67]
    ds_read_b128 v[136:139], v1 offset:63488
    v_mfma_f32_16x16x32_bf16 v[68:71], v[104:107], v[196:199], v[68:71]
    v_mfma_f32_16x16x32_bf16 v[72:75], v[108:111], v[192:195], v[72:75]
    ds_read_b128 v[140:143], v1 offset:64512
    v_mfma_f32_16x16x32_bf16 v[76:79], v[108:111], v[196:199], v[76:79]
    s_waitcnt lgkmcnt(0)
    v_mfma_f32_16x16x32_bf16 v[48:51], v[128:131], v[200:203], v[48:51]
    v_mfma_f32_16x16x32_bf16 v[56:59], v[132:135], v[200:203], v[56:59]
    v_mfma_f32_16x16x32_bf16 v[52:55], v[128:131], v[204:207], v[52:55]
    v_mfma_f32_16x16x32_bf16 v[60:63], v[132:135], v[204:207], v[60:63]
    v_mfma_f32_16x16x32_bf16 v[64:67], v[136:139], v[200:203], v[64:67]
    v_mfma_f32_16x16x32_bf16 v[72:75], v[140:143], v[200:203], v[72:75]
    s_nop 2
    v_cvt_pk_bf16_f32 v80, v48, v49
    v_cvt_pk_bf16_f32 v81, v50, v51
    v_cvt_pk_bf16_f32 v82, v56, v57
    v_cvt_pk_bf16_f32 v83, v58, v59
    v_mfma_f32_16x16x32_bf16 v[68:71], v[136:139], v[204:207], v[68:71]
    buffer_store_dwordx4 v[80:83], v1, s[8:11], s38 offen offset:0 sc1
    v_mfma_f32_16x16x32_bf16 v[76:79], v[140:143], v[204:207], v[76:79]
    v_cvt_pk_bf16_f32 v84, v52, v53
    v_cvt_pk_bf16_f32 v85, v54, v55
    v_cvt_pk_bf16_f32 v86, v60, v61
    v_cvt_pk_bf16_f32 v87, v62, v63
    v_mfma_f32_16x16x32_bf16 v[16:19], v[112:115], v[200:203], v[16:19]
    buffer_store_dwordx4 v[84:87], v1, s[8:11], s38 offen offset:1024 sc1
    v_mfma_f32_16x16x32_bf16 v[20:23], v[112:115], v[204:207], v[20:23]
    v_cvt_pk_bf16_f32 v88, v64, v65
    v_cvt_pk_bf16_f32 v89, v66, v67
    v_cvt_pk_bf16_f32 v90, v72, v73
    v_cvt_pk_bf16_f32 v91, v74, v75
    v_mfma_f32_16x16x32_bf16 v[24:27], v[116:119], v[200:203], v[24:27]
    buffer_store_dwordx4 v[88:91], v1, s[8:11], s38 offen offset:2048 sc1
    v_mfma_f32_16x16x32_bf16 v[28:31], v[116:119], v[204:207], v[28:31]
    v_cvt_pk_bf16_f32 v92, v68, v69
    v_cvt_pk_bf16_f32 v93, v70, v71
    v_cvt_pk_bf16_f32 v94, v76, v77
    v_cvt_pk_bf16_f32 v95, v78, v79
    v_mfma_f32_16x16x32_bf16 v[32:35], v[120:123], v[200:203], v[32:35]
    buffer_store_dwordx4 v[92:95], v1, s[8:11], s38 offen offset:3072 sc1
    v_mfma_f32_16x16x32_bf16 v[36:39], v[120:123], v[204:207], v[36:39]
    v_mfma_f32_16x16x32_bf16 v[40:43], v[124:127], v[200:203], v[40:43]
    v_mfma_f32_16x16x32_bf16 v[44:47], v[124:127], v[204:207], v[44:47]
    s_mov_b32 s31, 128
    buffer_load_dwordx4 v[160:163], v1, s[8:11], s46 offen offset:0 sc1
    buffer_load_dwordx4 v[164:167], v1, s[8:11], s46 offen offset:1024 sc1
    buffer_load_dwordx4 v[168:171], v1, s[8:11], s46 offen offset:2048 sc1
    buffer_load_dwordx4 v[172:175], v1, s[8:11], s46 offen offset:3072 sc1
    s_waitcnt vmcnt(8)
    v_mfma_f32_16x16x32_bf16 v[16:19], v[8:11], v[208:211], v[16:19]
    v_mfma_f32_16x16x32_bf16 v[24:27], v[12:15], v[208:211], v[24:27]
    v_mfma_f32_16x16x32_bf16 v[20:23], v[8:11], v[212:215], v[20:23]
    v_mfma_f32_16x16x32_bf16 v[28:31], v[12:15], v[212:215], v[28:31]
    v_mfma_f32_16x16x32_bf16 v[32:35], v[8:11], v[216:219], v[32:35]
    v_mfma_f32_16x16x32_bf16 v[40:43], v[12:15], v[216:219], v[40:43]
    v_mfma_f32_16x16x32_bf16 v[36:39], v[8:11], v[220:223], v[36:39]
    v_mfma_f32_16x16x32_bf16 v[44:47], v[12:15], v[220:223], v[44:47]
    s_branch K5_POLLW
K5_POLL:
    buffer_load_dwordx4 v[160:163], v1, s[8:11], s46 offen offset:0 sc1
    buffer_load_dwordx4 v[164:167], v1, s[8:11], s46 offen offset:1024 sc1
    buffer_load_dwordx4 v[168:171], v1, s[8:11], s46 offen offset:2048 sc1
    buffer_load_dwordx4 v[172:175], v1, s[8:11], s46 offen offset:3072 sc1
K5_POLLW:
    s_waitcnt vmcnt(0)
    v_mfma_f32_16x16x32_bf16 v[112:115], v[8:11], v[160:163], v[16:19]
    v_max3_u32 v7, v160, v161, v162
    v_mfma_f32_16x16x32_bf16 v[120:123], v[12:15], v[160:163], v[24:27]
    v_max3_u32 v6, v163, v164, v165
    v_mfma_f32_16x16x32_bf16 v[116:119], v[8:11], v[164:167], v[20:23]
    v_max3_u32 v7, v7, v166, v167
    v_mfma_f32_16x16x32_bf16 v[124:127], v[12:15], v[164:167], v[28:31]
    v_max3_u32 v6, v6, v168, v169
    v_mfma_f32_16x16x32_bf16 v[128:131], v[8:11], v[168:171], v[32:35]
    v_max3_u32 v7, v7, v170, v171
    v_mfma_f32_16x16x32_bf16 v[136:139], v[12:15], v[168:171], v[40:43]
    v_max3_u32 v6, v6, v172, v173
    v_mfma_f32_16x16x32_bf16 v[132:135], v[8:11], v[172:175], v[36:39]
    v_max3_u32 v7, v7, v174, v175
    v_mfma_f32_16x16x32_bf16 v[140:143], v[12:15], v[172:175], v[44:47]
    v_max_u32 v7, v7, v6
    v_cmp_eq_u32 vcc, -1, v7
    s_nop 4
    s_cbranch_vccz K5_GOT
    s_sub_u32 s31, s31, 1
    s_cmp_lg_u32 s31, 0
    s_cbranch_scc1 K5_POLL
    s_branch K5_SOLO
K5_GOT:
    v_cvt_pk_bf16_f32 v96, v112, v113
    v_cvt_pk_bf16_f32 v97, v114, v115
    v_cvt_pk_bf16_f32 v98, v120, v121
    v_cvt_pk_bf16_f32 v99, v122, v123
    s_nop 0
    v_permlane16_swap_b32 v96, v98
    v_permlane16_swap_b32 v97, v99
    buffer_store_dwordx4 v[96:99], v2, s[12:15], s34 offen offset:0 sc1
    v_cvt_pk_bf16_f32 v100, v128, v129
    v_cvt_pk_bf16_f32 v101, v130, v131
    v_cvt_pk_bf16_f32 v102, v136, v137
    v_cvt_pk_bf16_f32 v103, v138, v139
    s_nop 0
    v_permlane16_swap_b32 v100, v102
    v_permlane16_swap_b32 v101, v103
    buffer_store_dwordx4 v[100:103], v2, s[12:15], s34 offen offset:64 sc1
    v_cvt_pk_bf16_f32 v104, v116, v117
    v_cvt_pk_bf16_f32 v105, v118, v119
    v_cvt_pk_bf16_f32 v106, v124, v125
    v_cvt_pk_bf16_f32 v107, v126, v127
    s_nop 0
    v_permlane16_swap_b32 v104, v106
    v_permlane16_swap_b32 v105, v107
    buffer_store_dwordx4 v[104:107], v2, s[12:15], s37 offen offset:0 sc1
    v_cvt_pk_bf16_f32 v108, v132, v133
    v_cvt_pk_bf16_f32 v109, v134, v135
    v_cvt_pk_bf16_f32 v110, v140, v141
    v_cvt_pk_bf16_f32 v111, v142, v143
    s_nop 0
    v_permlane16_swap_b32 v108, v110
    v_permlane16_swap_b32 v109, v111
    buffer_store_dwordx4 v[108:111], v2, s[12:15], s37 offen offset:64 sc1
K5_END:
    s_endpgm
K5_SOLO:
    s_xor_b32 s20, s20, 1
    s_mul_i32 s24, s20, 7168
    s_add_u32 s24, s24, s32
    s_lshl_b32 s24, s24, 10
    s_add_u32 s24, s24, 4194304
    s_mul_i32 s25, s21, 112
    s_mul_i32 s26, s20, 56
    s_add_u32 s25, s25, s26
    s_lshl_b32 s25, s25, 1
    s_xor_b32 s26, s20, 1
    s_add_u32 s25, s25, s26
    s_lshl_b32 s25, s25, 12
    s_add_u32 s25, s25, 50331648
    s_mov_b32 s31, 14
K5_SOLO_L:
    buffer_load_dwordx4 v[80:83], v1, s[8:11], s25 offen offset:0
    buffer_load_dwordx4 v[84:87], v1, s[8:11], s25 offen offset:1024
    buffer_load_dwordx4 v[88:91], v1, s[8:11], s25 offen offset:2048
    buffer_load_dwordx4 v[92:95], v1, s[8:11], s25 offen offset:3072
    s_add_u32 s25, s25, 8192
    buffer_load_dwordx4 v[144:147], v1, s[8:11], s24 offen offset:0
    buffer_load_dwordx4 v[148:151], v1, s[8:11], s24 offen offset:1024
    s_add_u32 s24, s24, 131072
    buffer_load_dwordx4 v[96:99], v1, s[8:11], s25 offen offset:0
    buffer_load_dwordx4 v[100:103], v1, s[8:11], s25 offen offset:1024
    buffer_load_dwordx4 v[104:107], v1, s[8:11], s25 offen offset:2048
    buffer_load_dwordx4 v[108:111], v1, s[8:11], s25 offen offset:3072
    s_add_u32 s25, s25, 8192
    buffer_load_dwordx4 v[152:155], v1, s[8:11], s24 offen offset:0
    buffer_load_dwordx4 v[156:159], v1, s[8:11], s24 offen offset:1024
    s_add_u32 s24, s24, 131072
    buffer_load_dwordx4 v[112:115], v1, s[8:11], s25 offen offset:0
    buffer_load_dwordx4 v[116:119], v1, s[8:11], s25 offen offset:1024
    buffer_load_dwordx4 v[120:123], v1, s[8:11], s25 offen offset:2048
    buffer_load_dwordx4 v[124:127], v1, s[8:11], s25 offen offset:3072
    s_add_u32 s25, s25, 8192
    buffer_load_dwordx4 v[160:163], v1, s[8:11], s24 offen offset:0
    buffer_load_dwordx4 v[164:167], v1, s[8:11], s24 offen offset:1024
    s_add_u32 s24, s24, 131072
    buffer_load_dwordx4 v[128:131], v1, s[8:11], s25 offen offset:0
    buffer_load_dwordx4 v[132:135], v1, s[8:11], s25 offen offset:1024
    buffer_load_dwordx4 v[136:139], v1, s[8:11], s25 offen offset:2048
    buffer_load_dwordx4 v[140:143], v1, s[8:11], s25 offen offset:3072
    s_add_u32 s25, s25, 8192
    buffer_load_dwordx4 v[168:171], v1, s[8:11], s24 offen offset:0
    buffer_load_dwordx4 v[172:175], v1, s[8:11], s24 offen offset:1024
    s_add_u32 s24, s24, 131072
    s_waitcnt vmcnt(0)
    v_mfma_f32_16x16x32_bf16 v[16:19], v[80:83], v[144:147], v[16:19]
    v_mfma_f32_16x16x32_bf16 v[20:23], v[80:83], v[148:151], v[20:23]
    v_mfma_f32_16x16x32_bf16 v[24:27], v[84:87], v[144:147], v[24:27]
    v_mfma_f32_16x16x32_bf16 v[28:31], v[84:87], v[148:151], v[28:31]
    v_mfma_f32_16x16x32_bf16 v[32:35], v[88:91], v[144:147], v[32:35]
    v_mfma_f32_16x16x32_bf16 v[36:39], v[88:91], v[148:151], v[36:39]
    v_mfma_f32_16x16x32_bf16 v[40:43], v[92:95], v[144:147], v[40:43]
    v_mfma_f32_16x16x32_bf16 v[44:47], v[92:95], v[148:151], v[44:47]
    v_mfma_f32_16x16x32_bf16 v[16:19], v[96:99], v[152:155], v[16:19]
    v_mfma_f32_16x16x32_bf16 v[20:23], v[96:99], v[156:159], v[20:23]
    v_mfma_f32_16x16x32_bf16 v[24:27], v[100:103], v[152:155], v[24:27]
    v_mfma_f32_16x16x32_bf16 v[28:31], v[100:103], v[156:159], v[28:31]
    v_mfma_f32_16x16x32_bf16 v[32:35], v[104:107], v[152:155], v[32:35]
    v_mfma_f32_16x16x32_bf16 v[36:39], v[104:107], v[156:159], v[36:39]
    v_mfma_f32_16x16x32_bf16 v[40:43], v[108:111], v[152:155], v[40:43]
    v_mfma_f32_16x16x32_bf16 v[44:47], v[108:111], v[156:159], v[44:47]
    v_mfma_f32_16x16x32_bf16 v[16:19], v[112:115], v[160:163], v[16:19]
    v_mfma_f32_16x16x32_bf16 v[20:23], v[112:115], v[164:167], v[20:23]
    v_mfma_f32_16x16x32_bf16 v[24:27], v[116:119], v[160:163], v[24:27]
    v_mfma_f32_16x16x32_bf16 v[28:31], v[116:119], v[164:167], v[28:31]
    v_mfma_f32_16x16x32_bf16 v[32:35], v[120:123], v[160:163], v[32:35]
    v_mfma_f32_16x16x32_bf16 v[36:39], v[120:123], v[164:167], v[36:39]
    v_mfma_f32_16x16x32_bf16 v[40:43], v[124:127], v[160:163], v[40:43]
    v_mfma_f32_16x16x32_bf16 v[44:47], v[124:127], v[164:167], v[44:47]
    v_mfma_f32_16x16x32_bf16 v[16:19], v[128:131], v[168:171], v[16:19]
    v_mfma_f32_16x16x32_bf16 v[20:23], v[128:131], v[172:175], v[20:23]
    v_mfma_f32_16x16x32_bf16 v[24:27], v[132:135], v[168:171], v[24:27]
    v_mfma_f32_16x16x32_bf16 v[28:31], v[132:135], v[172:175], v[28:31]
    v_mfma_f32_16x16x32_bf16 v[32:35], v[136:139], v[168:171], v[32:35]
    v_mfma_f32_16x16x32_bf16 v[36:39], v[136:139], v[172:175], v[36:39]
    v_mfma_f32_16x16x32_bf16 v[40:43], v[140:143], v[168:171], v[40:43]
    v_mfma_f32_16x16x32_bf16 v[44:47], v[140:143], v[172:175], v[44:47]
    s_sub_u32 s31, s31, 1
    s_cmp_lg_u32 s31, 0
    s_cbranch_scc1 K5_SOLO_L
    v_mov_b32 v112, v16
    v_mov_b32 v113, v17
    v_mov_b32 v114, v18
    v_mov_b32 v115, v19
    v_mov_b32 v116, v20
    v_mov_b32 v117, v21
    v_mov_b32 v118, v22
    v_mov_b32 v119, v23
    v_mov_b32 v120, v24
    v_mov_b32 v121, v25
    v_mov_b32 v122, v26
    v_mov_b32 v123, v27
    v_mov_b32 v124, v28
    v_mov_b32 v125, v29
    v_mov_b32 v126, v30
    v_mov_b32 v127, v31
    v_mov_b32 v128, v32
    v_mov_b32 v129, v33
    v_mov_b32 v130, v34
    v_mov_b32 v131, v35
    v_mov_b32 v132, v36
    v_mov_b32 v133, v37
    v_mov_b32 v134, v38
    v_mov_b32 v135, v39
    v_mov_b32 v136, v40
    v_mov_b32 v137, v41
    v_mov_b32 v138, v42
    v_mov_b32 v139, v43
    v_mov_b32 v140, v44
    v_mov_b32 v141, v45
    v_mov_b32 v142, v46
    v_mov_b32 v143, v47
    s_branch K5_GOT
TEXT_END:
.section .rodata,"a"
.p2align 6
.amdhsa_kernel qkv_kernel
  .amdhsa_next_free_vgpr 176
  .amdhsa_next_free_sgpr 96
  .amdhsa_accum_offset 176
  .amdhsa_group_segment_fixed_size 0
  .amdhsa_kernarg_size 80
  .amdhsa_user_sgpr_count 2
  .amdhsa_user_sgpr_kernarg_segment_ptr 1
  .amdhsa_system_sgpr_workgroup_id_x 1
.end_amdhsa_kernel
.p2align 6
.amdhsa_kernel attn_kernel
  .amdhsa_next_free_vgpr 149
  .amdhsa_next_free_sgpr 96
  .amdhsa_accum_offset 152
  .amdhsa_group_segment_fixed_size 0
  .amdhsa_kernarg_size 80
  .amdhsa_user_sgpr_count 2
  .amdhsa_user_sgpr_kernarg_segment_ptr 1
  .amdhsa_system_sgpr_workgroup_id_x 1
.end_amdhsa_kernel
.p2align 6
.amdhsa_kernel wo_kernel
  .amdhsa_next_free_vgpr 128
  .amdhsa_next_free_sgpr 96
  .amdhsa_accum_offset 128
  .amdhsa_group_segment_fixed_size 0
  .amdhsa_kernarg_size 80
  .amdhsa_user_sgpr_count 2
  .amdhsa_user_sgpr_kernarg_segment_ptr 1
  .amdhsa_system_sgpr_workgroup_id_x 1
.end_amdhsa_kernel
.p2align 6
.amdhsa_kernel gu_kernel
  .amdhsa_next_free_vgpr 256
  .amdhsa_next_free_sgpr 96
  .amdhsa_accum_offset 256
  .amdhsa_group_segment_fixed_size 0
  .amdhsa_kernarg_size 80
  .amdhsa_user_sgpr_count 2
  .amdhsa_user_sgpr_kernarg_segment_ptr 1
  .amdhsa_system_sgpr_workgroup_id_x 1
.end_amdhsa_kernel
.p2align 6
.amdhsa_kernel down_kernel
  .amdhsa_next_free_vgpr 224
  .amdhsa_next_free_sgpr 96
  .amdhsa_accum_offset 224
  .amdhsa_group_segment_fixed_size 0
  .amdhsa_kernarg_size 80
  .amdhsa_user_sgpr_count 2
  .amdhsa_user_sgpr_kernarg_segment_ptr 1
  .amdhsa_system_sgpr_workgroup_id_x 1
.end_amdhsa_kernel
```
